```python
import torch

def _softmax(x, axis=-1):
    return torch.softmax(x, dim=axis)

def _gelu(x):
    return torch.nn.functional.gelu(x, approximate='tanh')

def _silu(x):
    return torch.nn.functional.silu(x)

def _sigmoid(x):
    return torch.sigmoid(x)

def _layernorm(x, axis=-1, eps=1e-05):
    m = x.mean(dim=axis, keepdim=True)
    v = x.var(dim=axis, keepdim=True, unbiased=False)
    return (x - m) / torch.sqrt(v + eps)

def _scatter_add(tgt, idx, src, axis=0):
    return tgt.clone().index_add_(axis, idx, src)

def _segment_sum(src, seg, n):
    out = torch.zeros((n,) + src.shape[1:], dtype=src.dtype)
    return out.index_add_(0, seg, src)

def _pad(x, pw):
    flat = tuple((v for pair in reversed(pw) for v in pair))
    return torch.nn.functional.pad(x, flat)
kernel_name = 'adaLN_cond__mha_block_cached__mixer_channel_mlp__decode'

def setup_inputs():

    _w = lambda a: (lambda t: t.to(torch.bfloat16) if t.is_floating_point() else t)(torch.as_tensor(a))

    def _A_setup():
        B, Sq, D = (1, 1, 512)
        H, Sk, Dh = (32, 4096, 128)
        return {'x': _w((lambda *s: torch.randn(*s, dtype=torch.bfloat16) * 0.1)(B, Sq, D)), 'k_cache': _w((lambda *s: torch.randn(*s, dtype=torch.bfloat16) * 0.8)(B, H, Sk, Dh)), 'v_cache': _w((lambda *s: torch.randn(*s, dtype=torch.bfloat16) * 0.8)(B, H, Sk, Dh)), 'wq': _w((lambda *s: torch.randn(*s, dtype=torch.bfloat16) * 0.8)(D, H * Dh) * D ** (-0.5)), 'wo': _w((lambda *s: torch.randn(*s, dtype=torch.bfloat16) * 0.8)(H * Dh, D) * (H * Dh) ** (-0.5))}
    _A_in = _A_setup()

    def _B_setup():
        B, S, D, F = (1, 1, 512, 1376)
        return {'x': _w((lambda *s: torch.randn(*s, dtype=torch.bfloat16) * 0.1)(B, S, D)), 'w1': _w((lambda *s: torch.randn(*s, dtype=torch.bfloat16) * 3.2)(D, F) * D ** (-0.5)), 'b1': _w((lambda *s: torch.randn(*s, dtype=torch.bfloat16) * 3.2)(F)), 'w2': _w((lambda *s: torch.randn(*s, dtype=torch.bfloat16) * 3.2)(F, D) * F ** (-0.5)), 'b2': _w((lambda *s: torch.randn(*s, dtype=torch.bfloat16) * 3.2)(D))}
    _B_in = _B_setup()
    return {'A_x': _A_in['x'], 'A_k_cache': _A_in['k_cache'], 'A_v_cache': _A_in['v_cache'], 'A_wq': _A_in['wq'], 'A_wo': _A_in['wo'], 'B_x': _B_in['x'], 'B_w1': _B_in['w1'], 'B_b1': _B_in['b1'], 'B_w2': _B_in['w2'], 'B_b2': _B_in['b2'], 'c': _w((lambda *s: torch.randn(*s, dtype=torch.bfloat16) * 0.4)(1, 512) * 8.0), 'w_mod': _w((lambda *s: torch.randn(*s, dtype=torch.bfloat16) * 0.4)(512, 6 * 512) * 512 ** (-0.5) * 8.0)}

def reference(A_x, A_k_cache, A_v_cache, A_wq, A_wo, B_x, B_w1, B_b1, B_w2, B_b2, c, w_mod):

    def _A_ref(x, k_cache, v_cache, wq, wo):
        B, Sq, D = x.shape
        H, Dh = (32, 128)
        q = (lambda x, *d: x.permute(*d))((x @ wq).reshape(B, Sq, H, Dh), 0, 2, 1, 3)
        scores = torch.einsum('bhqd,bhkd->bhqk', q, k_cache) * Dh ** (-0.5)
        p = _softmax(scores, axis=-1)
        o = torch.einsum('bhqk,bhkd->bhqd', p, v_cache)
        return (lambda x, *d: x.permute(*d))(o, 0, 2, 1, 3).reshape(B, Sq, H * Dh) @ wo

    def _B_ref(x, w1, b1, w2, b2):
        y = _layernorm(x, axis=-1)
        h = _gelu(torch.einsum('bsd,df->bsf', y, w1) + b1)
        return torch.einsum('bsf,fd->bsd', h, w2) + b2
    x = A_x
    mod = (_silu(c) @ w_mod).reshape(c.shape[0], 6, 1, -1)
    sa, ca, ga, sb, cb, gb = (mod[:, 0].clone(), mod[:, 1].clone(), mod[:, 2].clone(), mod[:, 3].clone(), mod[:, 4].clone(), mod[:, 5].clone())
    h = _layernorm(x, axis=-1) * (1 + ca) + sa
    x = x + ga * _A_ref(h, A_k_cache, A_v_cache, A_wq, A_wo)
    h = _layernorm(x, axis=-1) * (1 + cb) + sb
    x = x + gb * _B_ref(h, B_w1, B_b1, B_w2, B_b2)
    return x
```

```asm
; @launch grid=(256,1,1) block=(512,1,1) lds=21504
.amdgcn_target "amdgcn-amd-amdhsa--gfx950"
.text
.globl adaLN_cond__mha_block_cached__mixer_channel_mlp__decode_kernel
.p2align 12
.p2align 8
.type adaLN_cond__mha_block_cached__mixer_channel_mlp__decode_kernel,@function
adaLN_cond__mha_block_cached__mixer_channel_mlp__decode_kernel:
L_entry:
    s_load_dwordx16 s[16:31], s[0:1], 0
    s_load_dwordx8 s[32:39], s[0:1], 64
    s_load_dwordx4 s[40:43], s[0:1], 96
    s_load_dwordx2 s[44:45], s[0:1], 112
    s_cmp_ge_u32 s2, 256
    s_cbranch_scc1 L_end
    v_lshrrev_b32 v1, 6, v0
    v_and_b32 v0, 63, v0
    v_readfirstlane_b32 s3, v1
    s_and_b32 s4, s2, 7
    s_lshr_b32 s5, s2, 3
    s_and_b32 s9, s3, 3
    s_cmp_lt_u32 s5, 8
    s_cbranch_scc1 L_S
    s_sub_u32 s7, s5, 8
    s_and_b32 s6, s7, 3
    s_lshl_b32 s8, s4, 2
    s_add_u32 s6, s6, s8
    s_lshr_b32 s7, s7, 2
    s_cmp_lt_u32 s7, 4
    s_cselect_b32 s78, 1, 0
    s_mul_i32 s10, s7, 172
    s_cmp_eq_u32 s7, 5
    s_cselect_b32 s10, 856, s10
    s_add_u32 s10, s10, s9
    s_lshl_b32 s10, s10, 10
    s_lshl_b32 s11, s6, 20
    s_add_u32 s10, s10, s11
    v_lshl_add_u32 v1, v0, 4, s10
    s_mov_b32 s13, 4096
    s_mul_i32 s12, s2, 0x9E3779B1
    s_lshr_b32 s12, s12, 27
    s_mul_i32 s12, s12, s13
    s_add_u32 s79, s78, 42
    s_mul_i32 s79, s79, s13
    s_mov_b32 s54, 33554432
    s_mov_b32 s55, 0x20000
    s_cmp_ge_u32 s3, 4
    s_cbranch_scc0 L_Kiss
    v_mov_b32 v4, 0
    v_mov_b32 v5, 0
    v_mov_b32 v6, 0
    v_mov_b32 v7, 0
    ds_write_b128 v4, v[4:7] offset:3088
    s_waitcnt lgkmcnt(0)
    s_barrier
    s_branch L_Vpre
L_S:
    v_lshrrev_b32 v1, 3, v0
    v_and_b32 v3, 7, v0
    v_lshlrev_b32 v3, 4, v3
    s_movk_i32 s54, 1024
    s_mov_b32 s55, 0x20000
    s_mov_b32 s58, 3145728
    s_mov_b32 s59, 0x20000
    s_cmp_ge_u32 s3, 4
    s_cbranch_scc1 L_F
    s_lshr_b32 s8, s2, 1
    s_and_b32 s7, s2, 1
    s_mov_b32 s10, 49152
    v_mad_u32_u24 v2, v1, s10, v3
    s_lshl_b32 s10, s7, 2
    s_add_u32 s10, s10, s9
    s_lshl_b32 s11, s10, 7
    s_mul_i32 s10, s10, 393216
    s_lshl_b32 s12, s8, 7
    s_add_u32 s10, s10, s12
    v_lshlrev_b32 v18, 1, v0
    s_movk_i32 s12, 6144
    s_waitcnt lgkmcnt(0)
    s_mov_b32 s52, s36
    s_and_b32 s53, s37, 0xffff
    s_mov_b32 s56, s38
    s_and_b32 s57, s39, 0xffff
    buffer_load_ushort v8, v18, s[52:55], s11 offen
    buffer_load_dwordx4 v[64:67], v2, s[56:59], s10 offen nt
    s_add_u32 s10, s10, s12
    buffer_load_dwordx4 v[68:71], v2, s[56:59], s10 offen nt
    s_add_u32 s10, s10, s12
    buffer_load_dwordx4 v[72:75], v2, s[56:59], s10 offen nt
    s_add_u32 s10, s10, s12
    buffer_load_dwordx4 v[76:79], v2, s[56:59], s10 offen nt
    s_add_u32 s10, s10, s12
    buffer_load_dwordx4 v[80:83], v2, s[56:59], s10 offen nt
    s_add_u32 s10, s10, s12
    buffer_load_dwordx4 v[84:87], v2, s[56:59], s10 offen nt
    s_add_u32 s10, s10, s12
    buffer_load_dwordx4 v[88:91], v2, s[56:59], s10 offen nt
    s_add_u32 s10, s10, s12
    buffer_load_dwordx4 v[92:95], v2, s[56:59], s10 offen nt
    s_load_dword s46, s[44:45], 4
    s_barrier
    s_branch L_S0
L_F:
    v_mov_b32 v4, 0
    v_mov_b32 v5, 0
    v_mov_b32 v6, 0
    v_mov_b32 v7, 0
    ds_write_b128 v4, v[4:7] offset:6144
    ds_write_b128 v4, v[4:7] offset:6160
    v_mov_b32 v9, v3
    s_waitcnt lgkmcnt(0)
    s_barrier
    s_branch L_F0
L_Kiss:
    s_lshl_b32 s10, s5, 2
    s_add_u32 s10, s10, s9
    s_sub_u32 s10, s10, 32
    s_mul_i32 s11, s10, 43
    v_add_u32 v2, s11, v0
    v_and_b32 v3, 7, v2
    v_lshrrev_b32 v2, 3, v2
    v_lshlrev_b32 v2, 13, v2
    v_lshl_add_u32 v2, v3, 7, v2
    s_mul_i32 s11, s10, 11
    v_add_u32 v3, s11, v0
    v_and_b32 v4, 0xff, v3
    v_mul_u32_u24 v4, 6144, v4
    v_lshrrev_b32 v3, 8, v3
    v_lshl_add_u32 v3, v3, 9, v4
    s_lshl_b32 s10, s4, 10
    s_and_b32 s11, s4, 1
    s_mul_i32 s11, s11, 1572864
    s_lshr_b32 s14, s4, 1
    s_lshl_b32 s14, s14, 7
    s_add_u32 s11, s11, s14
    s_mov_b32 s58, 3145728
    s_mov_b32 s59, 0x20000
    s_mov_b32 s62, 4194304
    s_mov_b32 s63, 0x20000
    s_waitcnt lgkmcnt(0)
    s_mov_b32 s56, s38
    s_and_b32 s57, s39, 0xffff
    s_mov_b64 exec, 0x7ff
    buffer_load_dword v62, v3, s[56:59], s11 offen
    s_mov_b32 s60, s22
    s_and_b32 s61, s23, 0xffff
    s_mov_b32 exec_lo, 0xffffffff
    s_mov_b32 exec_hi, 0x7ff
    buffer_load_dword v63, v2, s[60:63], s10 offen
    s_mov_b32 exec_hi, -1
    s_mov_b32 s52, s18
    s_and_b32 s53, s19, 0xffff
    buffer_load_dwordx4 v[80:83], v1, s[52:55], s12 offen nt
    s_add_u32 s12, s12, s13
    s_cmp_eq_u32 s12, s79
    s_cselect_b32 s12, 0, s12
    buffer_load_dwordx4 v[84:87], v1, s[52:55], s12 offen nt
    s_add_u32 s12, s12, s13
    s_cmp_eq_u32 s12, s79
    s_cselect_b32 s12, 0, s12
    buffer_load_dwordx4 v[88:91], v1, s[52:55], s12 offen nt
    s_add_u32 s12, s12, s13
    s_cmp_eq_u32 s12, s79
    s_cselect_b32 s12, 0, s12
    buffer_load_dwordx4 v[92:95], v1, s[52:55], s12 offen nt
    s_add_u32 s12, s12, s13
    s_cmp_eq_u32 s12, s79
    s_cselect_b32 s12, 0, s12
    buffer_load_dwordx4 v[96:99], v1, s[52:55], s12 offen nt
    s_add_u32 s12, s12, s13
    s_cmp_eq_u32 s12, s79
    s_cselect_b32 s12, 0, s12
    buffer_load_dwordx4 v[100:103], v1, s[52:55], s12 offen nt
    s_add_u32 s12, s12, s13
    s_cmp_eq_u32 s12, s79
    s_cselect_b32 s12, 0, s12
    buffer_load_dwordx4 v[104:107], v1, s[52:55], s12 offen nt
    s_add_u32 s12, s12, s13
    s_cmp_eq_u32 s12, s79
    s_cselect_b32 s12, 0, s12
    buffer_load_dwordx4 v[108:111], v1, s[52:55], s12 offen nt
    s_add_u32 s12, s12, s13
    s_cmp_eq_u32 s12, s79
    s_cselect_b32 s12, 0, s12
    buffer_load_dwordx4 v[112:115], v1, s[52:55], s12 offen nt
    s_add_u32 s12, s12, s13
    s_cmp_eq_u32 s12, s79
    s_cselect_b32 s12, 0, s12
    buffer_load_dwordx4 v[116:119], v1, s[52:55], s12 offen nt
    s_add_u32 s12, s12, s13
    s_cmp_eq_u32 s12, s79
    s_cselect_b32 s12, 0, s12
    buffer_load_dwordx4 v[120:123], v1, s[52:55], s12 offen nt
    s_add_u32 s12, s12, s13
    s_cmp_eq_u32 s12, s79
    s_cselect_b32 s12, 0, s12
    s_load_dword s46, s[44:45], 4
    s_barrier
    buffer_load_dwordx4 v[124:127], v1, s[52:55], s12 offen nt
    s_add_u32 s12, s12, s13
    s_cmp_eq_u32 s12, s79
    s_cselect_b32 s12, 0, s12
    s_cmp_lt_u32 s9, 2
    s_cbranch_scc0 L_pfw1
    s_mov_b32 s56, s38
    s_and_b32 s57, s39, 0xffff
    s_mov_b32 s58, 3145728
    s_mov_b32 s59, 0x20000
    v_mul_u32_u24 v2, 6144, v0
    s_sub_u32 s10, s5, 8
    s_mul_i32 s10, s10, 135168
    s_lshl_b32 s11, s9, 3
    s_add_u32 s11, s11, s4
    s_add_u32 s11, s11, 32
    s_lshl_b32 s11, s11, 7
    s_add_u32 s10, s10, s11
    s_mov_b64 exec, 0x3fffff
    buffer_load_dword v60, v2, s[56:59], s10 offen
    s_mov_b64 exec, -1
    s_branch L_nopfw
L_pfw1:
    s_mov_b32 s56, s28
    s_and_b32 s57, s29, 0xffff
    s_mov_b32 s58, 1409024
    s_mov_b32 s59, 0x20000
    v_lshrrev_b32 v2, 2, v0
    v_mul_u32_u24 v2, 2752, v2
    v_and_b32 v3, 3, v0
    v_lshlrev_b32 v3, 7, v3
    v_min_u32 v3, 380, v3
    v_add_u32 v2, v2, v3
    s_lshl_b32 s10, s5, 1
    s_add_u32 s10, s10, s9
    s_sub_u32 s10, s10, 18
    s_mul_i32 s10, s10, 30272
    s_mul_i32 s11, s4, 384
    s_add_u32 s10, s10, s11
    s_mov_b32 exec_hi, 0xfff
    buffer_load_dword v60, v2, s[56:59], s10 offen
    s_mov_b32 exec_hi, -1
L_nopfw:
    s_mov_b32 s56, s24
    s_and_b32 s57, s25, 0xffff
    s_mov_b32 s58, 4194304
    s_mov_b32 s59, 0x20000
    v_lshlrev_b32 v2, 7, v0
    s_lshl_b32 s10, s5, 2
    s_add_u32 s10, s10, s9
    s_sub_u32 s10, s10, 32
    s_mul_i32 s10, s10, 5504
    s_lshl_b32 s11, s4, 19
    s_add_u32 s10, s10, s11
    s_mov_b32 exec_hi, 0x7ff
    buffer_load_dword v61, v2, s[56:59], s10 offen
    s_mov_b32 exec_hi, -1
    buffer_load_dwordx4 v[128:131], v1, s[52:55], s12 offen nt
    s_add_u32 s12, s12, s13
    s_cmp_eq_u32 s12, s79
    s_cselect_b32 s12, 0, s12
    buffer_load_dwordx4 v[132:135], v1, s[52:55], s12 offen nt
    s_add_u32 s12, s12, s13
    s_cmp_eq_u32 s12, s79
    s_cselect_b32 s12, 0, s12
    buffer_load_dwordx4 v[136:139], v1, s[52:55], s12 offen nt
    s_add_u32 s12, s12, s13
    s_cmp_eq_u32 s12, s79
    s_cselect_b32 s12, 0, s12
    buffer_load_dwordx4 v[140:143], v1, s[52:55], s12 offen nt
    s_add_u32 s12, s12, s13
    s_cmp_eq_u32 s12, s79
    s_cselect_b32 s12, 0, s12
    buffer_load_dwordx4 v[144:147], v1, s[52:55], s12 offen nt
    s_add_u32 s12, s12, s13
    s_cmp_eq_u32 s12, s79
    s_cselect_b32 s12, 0, s12
    buffer_load_dwordx4 v[148:151], v1, s[52:55], s12 offen nt
    s_add_u32 s12, s12, s13
    s_cmp_eq_u32 s12, s79
    s_cselect_b32 s12, 0, s12
    buffer_load_dwordx4 v[152:155], v1, s[52:55], s12 offen nt
    s_add_u32 s12, s12, s13
    s_cmp_eq_u32 s12, s79
    s_cselect_b32 s12, 0, s12
    buffer_load_dwordx4 v[156:159], v1, s[52:55], s12 offen nt
    s_add_u32 s12, s12, s13
    s_cmp_eq_u32 s12, s79
    s_cselect_b32 s12, 0, s12
    buffer_load_dwordx4 v[160:163], v1, s[52:55], s12 offen nt
    s_add_u32 s12, s12, s13
    s_cmp_eq_u32 s12, s79
    s_cselect_b32 s12, 0, s12
    buffer_load_dwordx4 v[164:167], v1, s[52:55], s12 offen nt
    s_add_u32 s12, s12, s13
    s_cmp_eq_u32 s12, s79
    s_cselect_b32 s12, 0, s12
    buffer_load_dwordx4 v[168:171], v1, s[52:55], s12 offen nt
    s_add_u32 s12, s12, s13
    s_cmp_eq_u32 s12, s79
    s_cselect_b32 s12, 0, s12
    buffer_load_dwordx4 v[172:175], v1, s[52:55], s12 offen nt
    s_add_u32 s12, s12, s13
    s_cmp_eq_u32 s12, s79
    s_cselect_b32 s12, 0, s12
    buffer_load_dwordx4 v[176:179], v1, s[52:55], s12 offen nt
    s_add_u32 s12, s12, s13
    s_cmp_eq_u32 s12, s79
    s_cselect_b32 s12, 0, s12
    buffer_load_dwordx4 v[180:183], v1, s[52:55], s12 offen nt
    s_add_u32 s12, s12, s13
    s_cmp_eq_u32 s12, s79
    s_cselect_b32 s12, 0, s12
    buffer_load_dwordx4 v[184:187], v1, s[52:55], s12 offen nt
    s_add_u32 s12, s12, s13
    s_cmp_eq_u32 s12, s79
    s_cselect_b32 s12, 0, s12
    buffer_load_dwordx4 v[188:191], v1, s[52:55], s12 offen nt
    s_add_u32 s12, s12, s13
    s_cmp_eq_u32 s12, s79
    s_cselect_b32 s12, 0, s12
    buffer_load_dwordx4 v[192:195], v1, s[52:55], s12 offen nt
    s_add_u32 s12, s12, s13
    s_cmp_eq_u32 s12, s79
    s_cselect_b32 s12, 0, s12
    buffer_load_dwordx4 v[196:199], v1, s[52:55], s12 offen nt
    s_add_u32 s12, s12, s13
    s_cmp_eq_u32 s12, s79
    s_cselect_b32 s12, 0, s12
    buffer_load_dwordx4 v[200:203], v1, s[52:55], s12 offen nt
    s_add_u32 s12, s12, s13
    s_cmp_eq_u32 s12, s79
    s_cselect_b32 s12, 0, s12
    buffer_load_dwordx4 v[204:207], v1, s[52:55], s12 offen nt
    s_add_u32 s12, s12, s13
    s_cmp_eq_u32 s12, s79
    s_cselect_b32 s12, 0, s12
    buffer_load_dwordx4 v[208:211], v1, s[52:55], s12 offen nt
    s_add_u32 s12, s12, s13
    s_cmp_eq_u32 s12, s79
    s_cselect_b32 s12, 0, s12
    buffer_load_dwordx4 v[212:215], v1, s[52:55], s12 offen nt
    s_add_u32 s12, s12, s13
    s_cmp_eq_u32 s12, s79
    s_cselect_b32 s12, 0, s12
    buffer_load_dwordx4 v[216:219], v1, s[52:55], s12 offen nt
    s_add_u32 s12, s12, s13
    s_cmp_eq_u32 s12, s79
    s_cselect_b32 s12, 0, s12
    buffer_load_dwordx4 v[220:223], v1, s[52:55], s12 offen nt
    s_add_u32 s12, s12, s13
    s_cmp_eq_u32 s12, s79
    s_cselect_b32 s12, 0, s12
    buffer_load_dwordx4 v[224:227], v1, s[52:55], s12 offen nt
    s_add_u32 s12, s12, s13
    s_cmp_eq_u32 s12, s79
    s_cselect_b32 s12, 0, s12
    buffer_load_dwordx4 v[228:231], v1, s[52:55], s12 offen nt
    s_add_u32 s12, s12, s13
    s_cmp_eq_u32 s12, s79
    s_cselect_b32 s12, 0, s12
    buffer_load_dwordx4 v[232:235], v1, s[52:55], s12 offen nt
    s_add_u32 s12, s12, s13
    s_cmp_eq_u32 s12, s79
    s_cselect_b32 s12, 0, s12
    buffer_load_dwordx4 v[236:239], v1, s[52:55], s12 offen nt
    s_add_u32 s12, s12, s13
    s_cmp_eq_u32 s12, s79
    s_cselect_b32 s12, 0, s12
    buffer_load_dwordx4 v[240:243], v1, s[52:55], s12 offen nt
    s_add_u32 s12, s12, s13
    s_cmp_eq_u32 s12, s79
    s_cselect_b32 s12, 0, s12
    buffer_load_dwordx4 v[244:247], v1, s[52:55], s12 offen nt
    s_add_u32 s12, s12, s13
    s_cmp_eq_u32 s12, s79
    s_cselect_b32 s12, 0, s12
    s_cmp_eq_u32 s78, 0
    s_cbranch_scc1 Lskip_1
    buffer_load_dwordx4 v[248:251], v1, s[52:55], s12 offen nt
Lskip_1:
    s_branch L_K
L_Vpre:
    s_waitcnt vmcnt(0) lgkmcnt(0)
    s_load_dword s46, s[44:45], 4
    s_mov_b32 s52, s20
    s_and_b32 s53, s21, 0xffff
    s_mov_b64 exec, 0
    s_cmp_eq_u32 s9, 0
    s_cbranch_scc1 Lhop_23
    s_cmp_eq_u32 s9, 1
    s_cbranch_scc1 Lhop_27
    s_cmp_eq_u32 s9, 2
    s_cbranch_scc1 Lhop_31
    s_branch Lhop_35
L_warmdonea:
    s_mov_b64 exec, -1
    s_branch L_V
L_S0:
    s_mov_b32 s48, s44
    s_and_b32 s49, s45, 0xffff
    s_mov_b32 s50, 1048576
    s_mov_b32 s51, 0x20000
    v_and_b32 v20, 1, v0
    v_lshlrev_b32 v20, 4, v20
    v_mov_b32 v21, 0xffff
    v_lshlrev_b32 v20, v20, v21
    v_bfe_u32 v21, v0, 1, 2
    v_cmp_eq_u32 vcc, 0, v21
    s_nop 1
    v_cndmask_b32 v4, 0, v20, vcc
    v_cmp_eq_u32 vcc, 1, v21
    s_nop 1
    v_cndmask_b32 v5, 0, v20, vcc
    v_cmp_eq_u32 vcc, 2, v21
    s_nop 1
    v_cndmask_b32 v6, 0, v20, vcc
    v_cmp_eq_u32 vcc, 3, v21
    s_nop 1
    v_cndmask_b32 v7, 0, v20, vcc
    v_and_b32 v16, 7, v0
    v_lshlrev_b32 v16, 5, v16
    v_and_b32 v17, 16, v0
    v_add_u32 v16, v16, v17
    v_and_b32 v17, 32, v0
    v_lshl_add_u32 v16, v17, 3, v16
    s_lshl_b32 s10, s9, 9
    v_add_u32 v16, s10, v16
    v_lshrrev_b32 v19, 4, v0
    v_lshlrev_b32 v17, 9, v19
    v_and_b32 v18, 15, v0
    v_lshl_add_u32 v17, v18, 4, v17
    v_lshl_add_u32 v18, v18, 2, v19
    v_mov_b32 v19, 0
    s_lshl_b32 s10, s9, 8
    v_lshl_add_u32 v2, v0, 2, s10
    v_lshl_add_u32 v9, v1, 5, s10
    s_waitcnt vmcnt(8) lgkmcnt(0)
    s_add_u32 s46, s46, 1
    s_and_b32 s47, s46, 0xff
    s_and_b32 s71, s46, 0xffff
    s_mov_b32 s72, 0xffffff00
    v_lshlrev_b32 v8, 16, v8
    v_mul_f32 v40, 0xbfb8aa3b, v8
    v_min_f32 v40, 0x42fc0000, v40
    v_exp_f32 v40, v40
    s_nop 0
    v_add_f32 v40, 1.0, v40
    v_rcp_f32 v41, v40
    s_nop 0
    v_mul_f32 v42, v8, v41
    v_fma_f32 v8, -v42, v40, v8
    v_fma_f32 v8, v8, v41, v42
    v_cvt_pk_bf16_f32 v8, v8, v8
    ds_write_b32 v2, v8 offset:10240
    ds_read_b128 v[44:47], v9 offset:10240
    ds_read_b128 v[48:51], v9 offset:10256
    s_waitcnt lgkmcnt(0)
    v_and_b32 v24, v44, v4
    v_and_b32 v25, v44, v5
    v_and_b32 v26, v44, v6
    v_and_b32 v27, v44, v7
    v_and_b32 v28, v45, v4
    v_and_b32 v29, v45, v5
    v_and_b32 v30, v45, v6
    v_and_b32 v31, v45, v7
    s_waitcnt vmcnt(4)
    v_mfma_f32_16x16x32_bf16 v[32:35], v[24:27], v[64:67], 0
    v_and_b32 v24, v46, v4
    v_and_b32 v25, v46, v5
    v_and_b32 v26, v46, v6
    v_and_b32 v27, v46, v7
    v_mfma_f32_16x16x32_bf16 v[32:35], v[28:31], v[68:71], v[32:35]
    v_and_b32 v28, v47, v4
    v_and_b32 v29, v47, v5
    v_and_b32 v30, v47, v6
    v_and_b32 v31, v47, v7
    v_mfma_f32_16x16x32_bf16 v[32:35], v[24:27], v[72:75], v[32:35]
    v_and_b32 v24, v48, v4
    v_and_b32 v25, v48, v5
    v_and_b32 v26, v48, v6
    v_and_b32 v27, v48, v7
    v_mfma_f32_16x16x32_bf16 v[32:35], v[28:31], v[76:79], v[32:35]
    v_and_b32 v28, v49, v4
    v_and_b32 v29, v49, v5
    v_and_b32 v30, v49, v6
    v_and_b32 v31, v49, v7
    s_waitcnt vmcnt(0)
    v_mfma_f32_16x16x32_bf16 v[32:35], v[24:27], v[80:83], v[32:35]
    v_and_b32 v24, v50, v4
    v_and_b32 v25, v50, v5
    v_and_b32 v26, v50, v6
    v_and_b32 v27, v50, v7
    v_mfma_f32_16x16x32_bf16 v[32:35], v[28:31], v[84:87], v[32:35]
    v_and_b32 v28, v51, v4
    v_and_b32 v29, v51, v5
    v_and_b32 v30, v51, v6
    v_and_b32 v31, v51, v7
    v_mfma_f32_16x16x32_bf16 v[32:35], v[24:27], v[88:91], v[32:35]
    s_nop 0
    v_mfma_f32_16x16x32_bf16 v[32:35], v[28:31], v[92:95], v[32:35]
    v_mov_b32 v22, 1
    s_mov_b32 exec_lo, 0xff00ff
    s_mov_b32 exec_hi, 0xff00ff00
    s_nop 4
    ds_write_b128 v16, v[32:35] offset:0
    s_mov_b64 exec, 1
    ds_add_rtn_u32 v22, v19, v22 offset:6144
    s_mov_b64 exec, -1
    ds_read_b128 v[40:43], v17 offset:0
    ds_read_b128 v[44:47], v17 offset:256
    s_waitcnt lgkmcnt(0)
    v_readfirstlane_b32 s10, v22
    s_cmp_lg_u32 s10, 3
    s_cbranch_scc1 L_Adone
    v_add_f32 v40, v40, v44
    v_add_f32 v41, v41, v45
    v_add_f32 v42, v42, v46
    v_add_f32 v43, v43, v47
    s_nop 0
    v_permlane32_swap_b32 v40, v42
    v_permlane32_swap_b32 v41, v43
    v_add_f32 v40, v40, v42
    v_add_f32 v41, v41, v43
    s_nop 1
    v_permlane16_swap_b32 v40, v41
    v_add_f32 v40, v40, v41
    s_cmp_lt_u32 s8, 16
    s_cbranch_scc0 L_Anarrow
    v_mov_b32 v41, s46
    v_lshlrev_b32 v2, 3, v18
    s_lshl_b32 s10, s8, 9
    s_lshl_b32 s11, s7, 13
    s_add_u32 s10, s10, s11
    s_add_u32 s10, s10, 4096
    buffer_store_dwordx2 v[40:41], v2, s[48:51], s10 offen sc1
    s_branch L_Adone
L_Anarrow:
    v_mov_b32 v41, s47
    v_lshlrev_b32 v2, 2, v18
    s_lshl_b32 s10, s8, 8
    s_lshl_b32 s11, s7, 13
    s_add_u32 s10, s10, s11
    s_add_u32 s10, s10, 16384
    v_and_or_b32 v40, v40, s72, v41
    buffer_store_dword v40, v2, s[48:51], s10 offen sc1
L_Adone:
    s_branch L_T
L_F0:
    s_load_dword s46, s[44:45], 4
    s_mov_b32 s52, s16
    s_and_b32 s53, s17, 0xffff
    v_lshlrev_b32 v2, 4, v0
    v_lshlrev_b32 v20, 2, v0
    s_lshl_b32 s11, s9, 8
    buffer_load_dwordx4 v[10:13], v2, s[52:55], 0 offen
    buffer_load_dword v14, v20, s[52:55], s11 offen
    s_mov_b32 s52, s36
    s_and_b32 s53, s37, 0xffff
    buffer_load_dword v8, v20, s[52:55], s11 offen
    s_mov_b32 s60, s22
    s_and_b32 s61, s23, 0xffff
    s_mov_b32 s62, 4194304
    s_mov_b32 s63, 0x20000
    v_lshl_add_u32 v15, v1, 17, v9
    s_lshl_b32 s10, s9, 20
    s_lshl_b32 s11, s4, 10
    s_add_u32 s10, s10, s11
    s_lshl_b32 s11, s5, 7
    s_add_u32 s70, s10, s11
    s_movk_i32 s12, 8192
    buffer_load_dwordx4 v[64:67], v15, s[60:63], s70 offen nt
    s_add_u32 s70, s70, s12
    buffer_load_dwordx4 v[68:71], v15, s[60:63], s70 offen nt
    s_add_u32 s70, s70, s12
    buffer_load_dwordx4 v[72:75], v15, s[60:63], s70 offen nt
    s_add_u32 s70, s70, s12
    buffer_load_dwordx4 v[76:79], v15, s[60:63], s70 offen nt
    s_add_u32 s70, s70, s12
    buffer_load_dwordx4 v[80:83], v15, s[60:63], s70 offen nt
    s_add_u32 s70, s70, s12
    buffer_load_dwordx4 v[84:87], v15, s[60:63], s70 offen nt
    s_add_u32 s70, s70, s12
    buffer_load_dwordx4 v[88:91], v15, s[60:63], s70 offen nt
    s_add_u32 s70, s70, s12
    buffer_load_dwordx4 v[92:95], v15, s[60:63], s70 offen nt
    s_add_u32 s70, s70, s12
    buffer_load_dwordx4 v[96:99], v15, s[60:63], s70 offen nt
    s_add_u32 s70, s70, s12
    buffer_load_dwordx4 v[100:103], v15, s[60:63], s70 offen nt
    s_add_u32 s70, s70, s12
    s_mov_b32 s48, s44
    s_and_b32 s49, s45, 0xffff
    s_mov_b32 s50, 1048576
    s_mov_b32 s51, 0x20000
    v_and_b32 v22, 1, v0
    v_lshlrev_b32 v22, 4, v22
    v_mov_b32 v23, 0xffff
    v_lshlrev_b32 v22, v22, v23
    v_bfe_u32 v23, v0, 1, 2
    v_cmp_eq_u32 vcc, 0, v23
    s_nop 1
    v_cndmask_b32 v4, 0, v22, vcc
    v_cmp_eq_u32 vcc, 1, v23
    s_nop 1
    v_cndmask_b32 v5, 0, v22, vcc
    v_cmp_eq_u32 vcc, 2, v23
    s_nop 1
    v_cndmask_b32 v6, 0, v22, vcc
    v_cmp_eq_u32 vcc, 3, v23
    s_nop 1
    v_cndmask_b32 v7, 0, v22, vcc
    v_and_b32 v16, 7, v0
    v_lshlrev_b32 v16, 5, v16
    v_and_b32 v17, 16, v0
    v_add_u32 v16, v16, v17
    v_and_b32 v17, 32, v0
    v_lshl_add_u32 v16, v17, 3, v16
    s_lshl_b32 s10, s9, 9
    v_add_u32 v16, s10, v16
    v_lshrrev_b32 v19, 4, v0
    v_lshlrev_b32 v17, 9, v19
    v_and_b32 v18, 15, v0
    v_lshl_add_u32 v17, v18, 4, v17
    v_lshl_add_u32 v18, v18, 2, v19
    v_mov_b32 v19, 0
    s_mov_b32 s10, 98304
    v_mad_u32_u24 v21, v1, s10, v9
    s_waitcnt vmcnt(10) lgkmcnt(0)
    s_add_u32 s46, s46, 1
    s_and_b32 s47, s46, 0xff
    s_and_b32 s71, s46, 0xffff
    s_mov_b32 s72, 0xffffff00
    v_lshlrev_b32 v44, 16, v10
    v_and_b32 v45, 0xffff0000, v10
    v_lshlrev_b32 v46, 16, v11
    v_and_b32 v47, 0xffff0000, v11
    v_lshlrev_b32 v48, 16, v12
    v_and_b32 v49, 0xffff0000, v12
    v_lshlrev_b32 v50, 16, v13
    v_and_b32 v51, 0xffff0000, v13
    v_add_f32 v10, v44, v45
    v_mul_f32 v11, v44, v44
    v_fmac_f32 v11, v45, v45
    v_add_f32 v10, v10, v46
    v_fmac_f32 v11, v46, v46
    v_add_f32 v10, v10, v47
    v_fmac_f32 v11, v47, v47
    v_add_f32 v10, v10, v48
    v_fmac_f32 v11, v48, v48
    v_add_f32 v10, v10, v49
    v_fmac_f32 v11, v49, v49
    v_add_f32 v10, v10, v50
    v_fmac_f32 v11, v50, v50
    v_add_f32 v10, v10, v51
    v_fmac_f32 v11, v51, v51
    s_nop 0
    v_add_f32_dpp v10, v10, v10 quad_perm:[1,0,3,2] row_mask:0xf bank_mask:0xf
    s_nop 1
    v_add_f32_dpp v10, v10, v10 quad_perm:[2,3,0,1] row_mask:0xf bank_mask:0xf
    s_nop 1
    v_add_f32_dpp v10, v10, v10 row_half_mirror row_mask:0xf bank_mask:0xf
    s_nop 1
    v_add_f32_dpp v10, v10, v10 row_mirror row_mask:0xf bank_mask:0xf
    v_add_f32_dpp v11, v11, v11 quad_perm:[1,0,3,2] row_mask:0xf bank_mask:0xf
    s_nop 1
    v_add_f32_dpp v11, v11, v11 quad_perm:[2,3,0,1] row_mask:0xf bank_mask:0xf
    s_nop 1
    v_add_f32_dpp v11, v11, v11 row_half_mirror row_mask:0xf bank_mask:0xf
    s_nop 1
    v_add_f32_dpp v11, v11, v11 row_mirror row_mask:0xf bank_mask:0xf
    v_mov_b32 v22, v10
    s_nop 1
    v_permlane16_swap_b32 v10, v22
    v_add_f32 v10, v10, v22
    v_mov_b32 v22, v10
    s_nop 1
    v_permlane32_swap_b32 v10, v22
    v_add_f32 v10, v10, v22
    v_mov_b32 v22, v11
    s_nop 1
    v_permlane16_swap_b32 v11, v22
    v_add_f32 v11, v11, v22
    v_mov_b32 v22, v11
    s_nop 1
    v_permlane32_swap_b32 v11, v22
    v_add_f32 v11, v11, v22
    v_mul_f32 v10, 0x3b000000, v10
    v_mul_f32 v11, 0x3b000000, v11
    v_fma_f32 v11, -v10, v10, v11
    v_cvt_pk_bf16_f32 v22, 0, v10
    v_max_f32 v11, 0, v11
    v_cvt_pk_bf16_f32 v12, 0, v11
    v_add_f32 v12, 0x3727c5ac, v12
    v_cvt_pk_bf16_f32 v12, 0, v12
    v_sqrt_f32 v12, v12
    s_nop 0
    v_cvt_pk_bf16_f32 v12, 0, v12
    v_rcp_f32 v23, v12
    v_lshlrev_b32 v12, 16, v14
    v_and_b32 v13, 0xffff0000, v14
    v_sub_f32 v12, v12, v22
    v_sub_f32 v13, v13, v22
    v_cvt_pk_bf16_f32 v12, 0, v12
    v_cvt_pk_bf16_f32 v13, 0, v13
    v_mul_f32 v12, v12, v23
    v_mul_f32 v13, v13, v23
    v_cvt_pk_bf16_f32 v12, 0, v12
    v_cvt_pk_bf16_f32 v13, 0, v13
    s_waitcnt vmcnt(9)
    buffer_load_dwordx4 v[104:107], v15, s[60:63], s70 offen nt
    s_add_u32 s70, s70, s12
    s_waitcnt vmcnt(9)
    buffer_load_dwordx4 v[108:111], v15, s[60:63], s70 offen nt
    s_add_u32 s70, s70, s12
    s_waitcnt vmcnt(9)
    buffer_load_dwordx4 v[112:115], v15, s[60:63], s70 offen nt
    s_add_u32 s70, s70, s12
    s_waitcnt vmcnt(9)
    buffer_load_dwordx4 v[116:119], v15, s[60:63], s70 offen nt
    s_add_u32 s70, s70, s12
    s_waitcnt vmcnt(9)
    buffer_load_dwordx4 v[120:123], v15, s[60:63], s70 offen nt
    s_add_u32 s70, s70, s12
    s_waitcnt vmcnt(9)
    buffer_load_dwordx4 v[124:127], v15, s[60:63], s70 offen nt
    s_lshl_b32 s10, s9, 10
    s_add_u32 s10, s10, 4096
    s_add_u32 s11, s10, 8192
    s_add_u32 s12, s10, 4096
    s_add_u32 s13, s10, 12288
    s_waitcnt vmcnt(0)
    s_mov_b32 s15, 0
    s_branch Lpoll_2
Lretry_3:
    s_add_u32 s15, s15, 1
    s_cmp_gt_u32 s15, 2000000
    s_cbranch_scc1 Ldone_4
    s_sleep 8
Lpoll_2:
    buffer_load_dwordx4 v[44:47], v2, s[48:51], s10 offen sc1
    buffer_load_dwordx4 v[48:51], v2, s[48:51], s11 offen sc1
    buffer_load_dwordx4 v[52:55], v2, s[48:51], s12 offen sc1
    buffer_load_dwordx4 v[56:59], v2, s[48:51], s13 offen sc1
    s_cmp_ge_u32 s5, 6
    s_cbranch_scc1 Lng_5
    v_mov_b32 v22, 1
    s_mov_b64 exec, 1
    ds_add_u32 v19, v22 offset:6156
    s_mov_b64 exec, -1
Lng_5:
    s_waitcnt vmcnt(0)
    v_xor_b32 v45, s46, v45
    v_xor_b32 v47, s46, v47
    v_xor_b32 v49, s46, v49
    v_xor_b32 v51, s46, v51
    v_xor_b32 v53, s46, v53
    v_xor_b32 v55, s46, v55
    v_xor_b32 v57, s46, v57
    v_xor_b32 v59, s46, v59
    v_or3_b32 v10, v45, v47, v49
    v_or3_b32 v11, v53, v55, v57
    v_or_b32 v10, v10, v51
    v_or_b32 v11, v11, v59
    v_or_b32 v10, v10, v11
    v_cmp_ne_u32 vcc, 0, v10
    s_cbranch_vccnz Lretry_3
Ldone_4:
    s_mov_b32 s56, s38
    s_and_b32 s57, s39, 0xffff
    s_cmp_lt_u32 s5, 6
    s_cbranch_scc1 L_noA2
    s_sub_u32 s8, s2, 16
    s_mul_i32 s70, s9, 786432
    s_lshl_b32 s11, s8, 7
    s_add_u32 s70, s70, s11
    buffer_load_dwordx4 v[128:131], v21, s[56:59], s70 offen
    s_add_u32 s70, s70, 6144
    buffer_load_dwordx4 v[132:135], v21, s[56:59], s70 offen
    s_add_u32 s70, s70, 6144
    buffer_load_dwordx4 v[136:139], v21, s[56:59], s70 offen
    s_add_u32 s70, s70, 6144
    buffer_load_dwordx4 v[140:143], v21, s[56:59], s70 offen
    s_add_u32 s70, s70, 6144
L_noA2:
    v_add_f32 v44, v44, v48
    v_add_f32 v52, v52, v56
    v_add_f32 v46, v46, v50
    v_add_f32 v54, v54, v58
    v_cvt_pk_bf16_f32 v44, 0, v44
    v_cvt_pk_bf16_f32 v46, 0, v46
    v_cvt_pk_bf16_f32 v52, 0, v52
    v_cvt_pk_bf16_f32 v54, 0, v54
    v_add_f32 v52, 1.0, v52
    v_add_f32 v54, 1.0, v54
    v_cvt_pk_bf16_f32 v52, 0, v52
    v_cvt_pk_bf16_f32 v54, 0, v54
    v_mul_f32 v12, v12, v52
    v_mul_f32 v13, v13, v54
    v_cvt_pk_bf16_f32 v12, 0, v12
    v_cvt_pk_bf16_f32 v13, 0, v13
    v_add_f32 v12, v12, v44
    v_add_f32 v13, v13, v46
    v_cvt_pk_bf16_f32 v12, v12, v12
    v_cvt_pk_bf16_f32 v13, v13, v13
    s_lshl_b32 s10, s9, 9
    v_lshl_add_u32 v2, v0, 3, s10
    v_lshl_add_u32 v3, v1, 6, s10
    ds_write_b64 v2, v[12:13] offset:8192
    ds_read_b128 v[192:195], v3 offset:8192
    ds_read_b128 v[196:199], v3 offset:8208
    ds_read_b128 v[200:203], v3 offset:8224
    ds_read_b128 v[204:207], v3 offset:8240
    s_waitcnt lgkmcnt(0)
    v_and_b32 v24, v192, v4
    v_and_b32 v25, v192, v5
    v_and_b32 v26, v192, v6
    v_and_b32 v27, v192, v7
    v_and_b32 v28, v193, v4
    v_and_b32 v29, v193, v5
    v_and_b32 v30, v193, v6
    v_and_b32 v31, v193, v7
    v_mfma_f32_16x16x32_bf16 v[32:35], v[24:27], v[64:67], 0
    v_and_b32 v24, v194, v4
    v_and_b32 v25, v194, v5
    v_and_b32 v26, v194, v6
    v_and_b32 v27, v194, v7
    v_mfma_f32_16x16x32_bf16 v[32:35], v[28:31], v[68:71], v[32:35]
    v_and_b32 v28, v195, v4
    v_and_b32 v29, v195, v5
    v_and_b32 v30, v195, v6
    v_and_b32 v31, v195, v7
    v_mfma_f32_16x16x32_bf16 v[32:35], v[24:27], v[72:75], v[32:35]
    v_and_b32 v24, v196, v4
    v_and_b32 v25, v196, v5
    v_and_b32 v26, v196, v6
    v_and_b32 v27, v196, v7
    v_mfma_f32_16x16x32_bf16 v[32:35], v[28:31], v[76:79], v[32:35]
    v_and_b32 v28, v197, v4
    v_and_b32 v29, v197, v5
    v_and_b32 v30, v197, v6
    v_and_b32 v31, v197, v7
    v_mfma_f32_16x16x32_bf16 v[32:35], v[24:27], v[80:83], v[32:35]
    v_and_b32 v24, v198, v4
    v_and_b32 v25, v198, v5
    v_and_b32 v26, v198, v6
    v_and_b32 v27, v198, v7
    v_mfma_f32_16x16x32_bf16 v[32:35], v[28:31], v[84:87], v[32:35]
    v_and_b32 v28, v199, v4
    v_and_b32 v29, v199, v5
    v_and_b32 v30, v199, v6
    v_and_b32 v31, v199, v7
    v_mfma_f32_16x16x32_bf16 v[32:35], v[24:27], v[88:91], v[32:35]
    v_and_b32 v24, v200, v4
    v_and_b32 v25, v200, v5
    v_and_b32 v26, v200, v6
    v_and_b32 v27, v200, v7
    v_mfma_f32_16x16x32_bf16 v[32:35], v[28:31], v[92:95], v[32:35]
    v_and_b32 v28, v201, v4
    v_and_b32 v29, v201, v5
    v_and_b32 v30, v201, v6
    v_and_b32 v31, v201, v7
    v_mfma_f32_16x16x32_bf16 v[32:35], v[24:27], v[96:99], v[32:35]
    v_and_b32 v24, v202, v4
    v_and_b32 v25, v202, v5
    v_and_b32 v26, v202, v6
    v_and_b32 v27, v202, v7
    v_mfma_f32_16x16x32_bf16 v[32:35], v[28:31], v[100:103], v[32:35]
    v_and_b32 v28, v203, v4
    v_and_b32 v29, v203, v5
    v_and_b32 v30, v203, v6
    v_and_b32 v31, v203, v7
    v_mfma_f32_16x16x32_bf16 v[32:35], v[24:27], v[104:107], v[32:35]
    v_and_b32 v24, v204, v4
    v_and_b32 v25, v204, v5
    v_and_b32 v26, v204, v6
    v_and_b32 v27, v204, v7
    v_mfma_f32_16x16x32_bf16 v[32:35], v[28:31], v[108:111], v[32:35]
    v_and_b32 v28, v205, v4
    v_and_b32 v29, v205, v5
    v_and_b32 v30, v205, v6
    v_and_b32 v31, v205, v7
    v_mfma_f32_16x16x32_bf16 v[32:35], v[24:27], v[112:115], v[32:35]
    v_and_b32 v24, v206, v4
    v_and_b32 v25, v206, v5
    v_and_b32 v26, v206, v6
    v_and_b32 v27, v206, v7
    v_mfma_f32_16x16x32_bf16 v[32:35], v[28:31], v[116:119], v[32:35]
    v_and_b32 v28, v207, v4
    v_and_b32 v29, v207, v5
    v_and_b32 v30, v207, v6
    v_and_b32 v31, v207, v7
    v_mfma_f32_16x16x32_bf16 v[32:35], v[24:27], v[120:123], v[32:35]
    s_nop 0
    v_mfma_f32_16x16x32_bf16 v[32:35], v[28:31], v[124:127], v[32:35]
    v_mov_b32 v22, 1
    s_mov_b32 exec_lo, 0xff00ff
    s_mov_b32 exec_hi, 0xff00ff00
    s_nop 4
    ds_write_b128 v16, v[32:35] offset:2048
    s_mov_b64 exec, 1
    ds_add_rtn_u32 v22, v19, v22 offset:6148
    s_mov_b64 exec, -1
    ds_read_b128 v[40:43], v17 offset:2048
    ds_read_b128 v[44:47], v17 offset:2304
    s_waitcnt lgkmcnt(0)
    v_readfirstlane_b32 s10, v22
    s_cmp_lg_u32 s10, 3
    s_cbranch_scc1 L_Bdone
    v_add_f32 v40, v40, v44
    v_add_f32 v41, v41, v45
    v_add_f32 v42, v42, v46
    v_add_f32 v43, v43, v47
    s_nop 0
    v_permlane32_swap_b32 v40, v42
    v_permlane32_swap_b32 v41, v43
    v_add_f32 v40, v40, v42
    v_add_f32 v41, v41, v43
    s_nop 1
    v_permlane16_swap_b32 v40, v41
    v_add_f32 v40, v40, v41
    v_cvt_pk_bf16_f32 v40, 0, v40
    v_or_b32 v40, s71, v40
    v_lshlrev_b32 v41, 2, v18
    s_lshl_b32 s10, s4, 11
    s_lshl_b32 s11, s5, 8
    s_add_u32 s10, s10, s11
    s_add_u32 s10, s10, 65536
    s_add_u32 s11, s10, 524288
    buffer_store_dword v40, v41, s[48:51], s10 offen
    buffer_store_dword v40, v41, s[48:51], s11 offen sc1
L_Bdone:
    s_cmp_lt_u32 s5, 6
    s_cbranch_scc1 L_sfin
    buffer_load_dwordx4 v[144:147], v21, s[56:59], s70 offen
    s_add_u32 s70, s70, 6144
    buffer_load_dwordx4 v[148:151], v21, s[56:59], s70 offen
    s_add_u32 s70, s70, 6144
    buffer_load_dwordx4 v[152:155], v21, s[56:59], s70 offen
    s_add_u32 s70, s70, 6144
    buffer_load_dwordx4 v[156:159], v21, s[56:59], s70 offen
    s_add_u32 s70, s70, 6144
    buffer_load_dwordx4 v[160:163], v21, s[56:59], s70 offen
    s_add_u32 s70, s70, 6144
    buffer_load_dwordx4 v[164:167], v21, s[56:59], s70 offen
    s_add_u32 s70, s70, 6144
    buffer_load_dwordx4 v[168:171], v21, s[56:59], s70 offen
    s_add_u32 s70, s70, 6144
    buffer_load_dwordx4 v[172:175], v21, s[56:59], s70 offen
    s_add_u32 s70, s70, 6144
    buffer_load_dwordx4 v[176:179], v21, s[56:59], s70 offen
    s_add_u32 s70, s70, 6144
    buffer_load_dwordx4 v[180:183], v21, s[56:59], s70 offen
    s_add_u32 s70, s70, 6144
    buffer_load_dwordx4 v[184:187], v21, s[56:59], s70 offen
    s_add_u32 s70, s70, 6144
    buffer_load_dwordx4 v[188:191], v21, s[56:59], s70 offen
    v_mov_b32 v22, 1
    s_mov_b64 exec, 1
    ds_add_u32 v19, v22 offset:6156
    s_mov_b64 exec, -1
    v_lshlrev_b32 v12, 16, v8
    v_and_b32 v13, 0xffff0000, v8
    v_mul_f32 v44, 0xbfb8aa3b, v12
    v_mul_f32 v45, 0xbfb8aa3b, v13
    v_min_f32 v44, 0x42fc0000, v44
    v_min_f32 v45, 0x42fc0000, v45
    v_exp_f32 v44, v44
    v_exp_f32 v45, v45
    v_add_f32 v44, 1.0, v44
    v_add_f32 v45, 1.0, v45
    v_rcp_f32 v46, v44
    v_rcp_f32 v47, v45
    v_mul_f32 v48, v12, v46
    v_mul_f32 v49, v13, v47
    v_fma_f32 v12, -v48, v44, v12
    v_fma_f32 v13, -v49, v45, v13
    v_fma_f32 v12, v12, v46, v48
    v_fma_f32 v13, v13, v47, v49
    v_cvt_pk_bf16_f32 v12, v12, v12
    v_cvt_pk_bf16_f32 v13, v13, v13
    ds_write_b64 v2, v[12:13] offset:8192
    ds_read_b128 v[192:195], v3 offset:8192
    ds_read_b128 v[196:199], v3 offset:8208
    ds_read_b128 v[200:203], v3 offset:8224
    ds_read_b128 v[204:207], v3 offset:8240
    s_waitcnt lgkmcnt(0)
    v_and_b32 v24, v192, v4
    v_and_b32 v25, v192, v5
    v_and_b32 v26, v192, v6
    v_and_b32 v27, v192, v7
    v_and_b32 v28, v193, v4
    v_and_b32 v29, v193, v5
    v_and_b32 v30, v193, v6
    v_and_b32 v31, v193, v7
    s_waitcnt vmcnt(8)
    v_mfma_f32_16x16x32_bf16 v[32:35], v[24:27], v[128:131], 0
    v_and_b32 v24, v194, v4
    v_and_b32 v25, v194, v5
    v_and_b32 v26, v194, v6
    v_and_b32 v27, v194, v7
    v_mfma_f32_16x16x32_bf16 v[32:35], v[28:31], v[132:135], v[32:35]
    v_and_b32 v28, v195, v4
    v_and_b32 v29, v195, v5
    v_and_b32 v30, v195, v6
    v_and_b32 v31, v195, v7
    v_mfma_f32_16x16x32_bf16 v[32:35], v[24:27], v[136:139], v[32:35]
    v_and_b32 v24, v196, v4
    v_and_b32 v25, v196, v5
    v_and_b32 v26, v196, v6
    v_and_b32 v27, v196, v7
    v_mfma_f32_16x16x32_bf16 v[32:35], v[28:31], v[140:143], v[32:35]
    v_and_b32 v28, v197, v4
    v_and_b32 v29, v197, v5
    v_and_b32 v30, v197, v6
    v_and_b32 v31, v197, v7
    v_mfma_f32_16x16x32_bf16 v[32:35], v[24:27], v[144:147], v[32:35]
    v_and_b32 v24, v198, v4
    v_and_b32 v25, v198, v5
    v_and_b32 v26, v198, v6
    v_and_b32 v27, v198, v7
    v_mfma_f32_16x16x32_bf16 v[32:35], v[28:31], v[148:151], v[32:35]
    v_and_b32 v28, v199, v4
    v_and_b32 v29, v199, v5
    v_and_b32 v30, v199, v6
    v_and_b32 v31, v199, v7
    v_mfma_f32_16x16x32_bf16 v[32:35], v[24:27], v[152:155], v[32:35]
    v_and_b32 v24, v200, v4
    v_and_b32 v25, v200, v5
    v_and_b32 v26, v200, v6
    v_and_b32 v27, v200, v7
    v_mfma_f32_16x16x32_bf16 v[32:35], v[28:31], v[156:159], v[32:35]
    v_and_b32 v28, v201, v4
    v_and_b32 v29, v201, v5
    v_and_b32 v30, v201, v6
    v_and_b32 v31, v201, v7
    s_waitcnt vmcnt(0)
    v_mfma_f32_16x16x32_bf16 v[32:35], v[24:27], v[160:163], v[32:35]
    v_and_b32 v24, v202, v4
    v_and_b32 v25, v202, v5
    v_and_b32 v26, v202, v6
    v_and_b32 v27, v202, v7
    v_mfma_f32_16x16x32_bf16 v[32:35], v[28:31], v[164:167], v[32:35]
    v_and_b32 v28, v203, v4
    v_and_b32 v29, v203, v5
    v_and_b32 v30, v203, v6
    v_and_b32 v31, v203, v7
    v_mfma_f32_16x16x32_bf16 v[32:35], v[24:27], v[168:171], v[32:35]
    v_and_b32 v24, v204, v4
    v_and_b32 v25, v204, v5
    v_and_b32 v26, v204, v6
    v_and_b32 v27, v204, v7
    v_mfma_f32_16x16x32_bf16 v[32:35], v[28:31], v[172:175], v[32:35]
    v_and_b32 v28, v205, v4
    v_and_b32 v29, v205, v5
    v_and_b32 v30, v205, v6
    v_and_b32 v31, v205, v7
    v_mfma_f32_16x16x32_bf16 v[32:35], v[24:27], v[176:179], v[32:35]
    v_and_b32 v24, v206, v4
    v_and_b32 v25, v206, v5
    v_and_b32 v26, v206, v6
    v_and_b32 v27, v206, v7
    v_mfma_f32_16x16x32_bf16 v[32:35], v[28:31], v[180:183], v[32:35]
    v_and_b32 v28, v207, v4
    v_and_b32 v29, v207, v5
    v_and_b32 v30, v207, v6
    v_and_b32 v31, v207, v7
    v_mfma_f32_16x16x32_bf16 v[32:35], v[24:27], v[184:187], v[32:35]
    s_nop 0
    v_mfma_f32_16x16x32_bf16 v[32:35], v[28:31], v[188:191], v[32:35]
    v_mov_b32 v22, 1
    s_mov_b32 exec_lo, 0xff00ff
    s_mov_b32 exec_hi, 0xff00ff00
    s_nop 4
    ds_write_b128 v16, v[32:35] offset:4096
    s_mov_b64 exec, 1
    ds_add_rtn_u32 v22, v19, v22 offset:6152
    s_mov_b64 exec, -1
    ds_read_b128 v[40:43], v17 offset:4096
    ds_read_b128 v[44:47], v17 offset:4352
    s_waitcnt lgkmcnt(0)
    v_readfirstlane_b32 s10, v22
    s_cmp_lg_u32 s10, 3
    s_cbranch_scc1 L_sfin
    v_add_f32 v40, v40, v44
    v_add_f32 v41, v41, v45
    v_add_f32 v42, v42, v46
    v_add_f32 v43, v43, v47
    s_nop 0
    v_permlane32_swap_b32 v40, v42
    v_permlane32_swap_b32 v41, v43
    v_add_f32 v40, v40, v42
    v_add_f32 v41, v41, v43
    s_nop 1
    v_permlane16_swap_b32 v40, v41
    v_add_f32 v40, v40, v41
    v_mov_b32 v42, s47
    v_lshlrev_b32 v41, 2, v18
    s_lshl_b32 s10, s8, 8
    s_add_u32 s10, s10, 16384
    s_add_u32 s11, s10, 8192
    v_and_or_b32 v40, v40, s72, v42
    buffer_store_dword v40, v41, s[48:51], s10 offen sc1
    buffer_store_dword v42, v41, s[48:51], s11 offen sc1
L_sfin:
    s_cmp_ge_u32 s5, 6
    s_cbranch_scc1 L_noprobef
    s_lshl_b32 s10, s9, 14
    s_lshl_b32 s11, s2, 7
    s_add_u32 s10, s10, s11
    s_add_u32 s10, s10, 786432
    s_add_u32 s11, s10, 8192
    s_mov_b32 s64, -1
    s_mov_b32 s65, -1
    s_mov_b32 s13, 0
L_probef:
    s_memtime s[66:67]
    s_waitcnt lgkmcnt(0)
    s_load_dword s12, s[44:45], s10 glc
    s_waitcnt lgkmcnt(0)
    s_memtime s[68:69]
    s_waitcnt lgkmcnt(0)
    s_sub_u32 s12, s68, s66
    s_min_u32 s64, s64, s12
    s_memtime s[66:67]
    s_waitcnt lgkmcnt(0)
    s_load_dword s12, s[44:45], s11 glc
    s_waitcnt lgkmcnt(0)
    s_memtime s[68:69]
    s_waitcnt lgkmcnt(0)
    s_sub_u32 s12, s68, s66
    s_min_u32 s65, s65, s12
    s_add_u32 s13, s13, 1
    s_cmp_lt_u32 s13, 5
    s_cbranch_scc1 L_probef
    v_mov_b32 v4, s64
    v_mov_b32 v5, s65
    s_lshl_b32 s10, s9, 3
    v_mov_b32 v6, s10
    v_mov_b32 v2, 0
    v_mov_b32 v7, 1
    s_mov_b64 exec, 1
    ds_write_b64 v6, v[4:5] offset:6656
    ds_add_u32 v2, v7 offset:6164
    s_mov_b64 exec, -1
    s_mov_b32 s15, 0
    v_mov_b32 v2, 0
Lspin_6:
    ds_read_b32 v3, v2 offset:6164
    ds_read_b128 v[56:59], v2 offset:6656
    ds_read_b128 v[60:63], v2 offset:6672
    s_waitcnt lgkmcnt(0)
    v_readfirstlane_b32 s14, v3
    s_add_u32 s15, s15, 1
    s_cmp_ge_u32 s14, 4
    s_cbranch_scc1 Lspd_7
    s_cmp_gt_u32 s15, 16000000
    s_cbranch_scc1 Lspd_7
    s_sleep 1
    s_branch Lspin_6
Lspd_7:
    v_min3_u32 v56, v56, v58, v60
    v_min3_u32 v57, v57, v59, v61
    v_min_u32 v56, v56, v62
    v_min_u32 v57, v57, v63
    v_cmp_lt_u32 vcc, v57, v56
    s_cmp_lg_u64 vcc, 0
    s_cselect_b32 s29, 8192, 0
    s_lshr_b32 s10, s9, 1
    s_lshl_b32 s10, s10, 14
    s_and_b32 s11, s9, 1
    s_lshl_b32 s11, s11, 12
    s_add_u32 s10, s10, s11
    v_lshlrev_b32 v4, 7, v0
    s_add_u32 s11, s10, s29
    s_add_u32 s11, s11, 262144
    s_mov_b32 exec_hi, 0
    buffer_load_dword v5, v4, s[48:51], s11 offen sc1
    s_lshl_b32 s11, s4, 9
    s_add_u32 s11, s11, s10
    s_add_u32 s11, s11, 294912
    s_mov_b64 exec, 15
    buffer_load_dword v6, v4, s[48:51], s11 offen sc1
    s_mov_b64 exec, -1
    s_mul_i32 s10, s4, 6
    s_add_u32 s10, s10, s5
    s_mov_b32 s52, s32
    s_and_b32 s53, s33, 0xffff
    s_mov_b32 s54, 1409024
    s_mov_b32 s55, 0x20000
    s_lshl_b32 s11, s10, 15
    s_mov_b64 exec, 1
    buffer_load_dword v8, v4, s[52:55], s11 offen nt
    s_mov_b64 exec, -1
    s_lshl_b32 s11, s9, 5
    s_add_u32 s11, s11, s10
    s_cmp_ge_u32 s11, 32
    s_cbranch_scc1 L_noprobef
    v_lshrrev_b32 v4, 2, v0
    v_lshlrev_b32 v4, 14, v4
    v_and_b32 v7, 3, v0
    v_lshl_add_u32 v4, v7, 11, v4
    s_lshl_b32 s10, s10, 6
    s_add_u32 s10, s10, s29
    s_add_u32 s10, s10, 327680
    s_mov_b32 exec_hi, 0x7ff
    buffer_load_dword v7, v4, s[48:51], s10 offen sc1
    s_mov_b32 exec_hi, -1
L_noprobef:
    s_endpgm
.p2align 12
L_T:
    s_mov_b64 exec, 0
    s_cmp_eq_u32 s9, 0
    s_cbranch_scc1 Lhop_0
    s_cmp_eq_u32 s9, 1
    s_cbranch_scc1 Lhop_6
    s_cmp_eq_u32 s9, 2
    s_cbranch_scc1 Lhop_12
    s_branch Lhop_17
L_warmdonet:
    s_mov_b64 exec, -1
    s_mov_b32 s15, 0
    v_mov_b32 v2, 0
Lspin_8:
    ds_read_b32 v3, v2 offset:6156
    s_waitcnt lgkmcnt(0)
    v_readfirstlane_b32 s14, v3
    s_add_u32 s15, s15, 1
    s_cmp_ge_u32 s14, 4
    s_cbranch_scc1 Lspd_9
    s_cmp_gt_u32 s15, 16000000
    s_cbranch_scc1 Lspd_9
    s_sleep 1
    s_branch Lspin_8
Lspd_9:
    v_and_b32 v3, 7, v0
    v_lshlrev_b32 v3, 4, v3
    v_lshl_add_u32 v2, v1, 14, v3
    s_mov_b32 s56, s24
    s_and_b32 s57, s25, 0xffff
    s_mov_b32 s58, 4194304
    s_mov_b32 s59, 0x20000
    s_lshl_b32 s10, s4, 19
    s_lshl_b32 s11, s9, 17
    s_add_u32 s10, s10, s11
    s_lshl_b32 s11, s5, 7
    s_add_u32 s10, s10, s11
    s_waitcnt vmcnt(4)
    buffer_load_dwordx4 v[64:67], v2, s[56:59], s10 offen offset:0
    s_waitcnt vmcnt(4)
    buffer_load_dwordx4 v[68:71], v2, s[56:59], s10 offen offset:1024
    s_waitcnt vmcnt(4)
    buffer_load_dwordx4 v[72:75], v2, s[56:59], s10 offen offset:2048
    s_waitcnt vmcnt(4)
    buffer_load_dwordx4 v[76:79], v2, s[56:59], s10 offen offset:3072
    s_add_u32 s10, s10, 4096
    s_waitcnt vmcnt(4)
    buffer_load_dwordx4 v[80:83], v2, s[56:59], s10 offen offset:0
    s_waitcnt vmcnt(4)
    buffer_load_dwordx4 v[84:87], v2, s[56:59], s10 offen offset:1024
    s_waitcnt vmcnt(4)
    buffer_load_dwordx4 v[88:91], v2, s[56:59], s10 offen offset:2048
    s_waitcnt vmcnt(4)
    buffer_load_dwordx4 v[92:95], v2, s[56:59], s10 offen offset:3072
    s_add_u32 s10, s10, 4096
    s_waitcnt vmcnt(4)
    buffer_load_dwordx4 v[96:99], v2, s[56:59], s10 offen offset:0
    s_waitcnt vmcnt(4)
    buffer_load_dwordx4 v[100:103], v2, s[56:59], s10 offen offset:1024
    s_waitcnt vmcnt(4)
    buffer_load_dwordx4 v[104:107], v2, s[56:59], s10 offen offset:2048
    s_waitcnt vmcnt(4)
Lhop_0:
    s_cbranch_execz Lhop_1
    buffer_load_dwordx4 v[108:111], v2, s[56:59], s10 offen offset:3072
    s_add_u32 s10, s10, 4096
    s_waitcnt vmcnt(4)
    buffer_load_dwordx4 v[112:115], v2, s[56:59], s10 offen offset:0
    s_waitcnt vmcnt(4)
    buffer_load_dwordx4 v[116:119], v2, s[56:59], s10 offen offset:1024
    s_waitcnt vmcnt(4)
    buffer_load_dwordx4 v[120:123], v2, s[56:59], s10 offen offset:2048
    s_waitcnt vmcnt(4)
    buffer_load_dwordx4 v[124:127], v2, s[56:59], s10 offen offset:3072
    s_mul_i32 s76, s4, 6
    s_add_u32 s76, s76, s5
    s_cmp_lt_u32 s5, 6
    s_cselect_b32 s76, s76, 100
    s_cmp_lt_u32 s76, 43
    s_cselect_b32 s77, 1, 0
    s_lshl_b32 s10, s9, 6
    v_add_u32 v17, s10, v0
    v_lshlrev_b32 v18, 4, v0
    v_lshlrev_b32 v20, 2, v0
    v_lshlrev_b32 v21, 3, v0
    v_lshlrev_b32 v23, 3, v17
    v_and_b32 v15, 3, v0
    s_lshl_b32 s78, s76, 4
    s_and_b32 s78, s78, 511
    v_lshrrev_b32 v34, 4, v0
    v_lshl_add_u32 v34, v15, 2, v34
    v_add_u32 v34, s78, v34
    v_lshlrev_b32 v35, 1, v34
    v_lshlrev_b32 v34, 2, v34
    v_lshrrev_b32 v33, 4, v0
    v_lshlrev_b32 v33, 3, v33
    v_lshl_add_u32 v33, v15, 1, v33
    v_and_b32 v2, 1, v1
    v_add_u32 v33, v33, v2
    s_cmp_eq_u32 s77, 0
    s_cbranch_scc1 L_nomlpw
    s_mov_b32 s60, s28
    s_and_b32 s61, s29, 0xffff
    s_mov_b32 s62, 1409024
    s_mov_b32 s63, 0x20000
    v_lshrrev_b32 v2, 2, v17
    s_movk_i32 s10, 22016
    v_mul_lo_u32 v2, v2, s10
    v_lshl_add_u32 v2, v15, 4, v2
    s_lshl_b32 s10, s76, 6
    s_waitcnt vmcnt(4)
    buffer_load_dwordx4 v[128:131], v2, s[60:63], s10 offen offset:0
    s_waitcnt vmcnt(4)
    buffer_load_dwordx4 v[132:135], v2, s[60:63], s10 offen offset:2752
    s_add_u32 s10, s10, 5504
    s_waitcnt vmcnt(4)
    buffer_load_dwordx4 v[136:139], v2, s[60:63], s10 offen offset:0
    s_waitcnt vmcnt(4)
    buffer_load_dwordx4 v[140:143], v2, s[60:63], s10 offen offset:2752
    s_add_u32 s10, s10, 5504
    s_waitcnt vmcnt(4)
    buffer_load_dwordx4 v[144:147], v2, s[60:63], s10 offen offset:0
    s_waitcnt vmcnt(4)
    buffer_load_dwordx4 v[148:151], v2, s[60:63], s10 offen offset:2752
    s_add_u32 s10, s10, 5504
    s_waitcnt vmcnt(4)
    buffer_load_dwordx4 v[152:155], v2, s[60:63], s10 offen offset:0
    s_waitcnt vmcnt(4)
    buffer_load_dwordx4 v[156:159], v2, s[60:63], s10 offen offset:2752
    s_mov_b32 s60, s16
    s_and_b32 s61, s17, 0xffff
    s_mov_b32 s62, 1024
    s_mov_b32 s63, 0x20000
    v_lshlrev_b32 v36, 2, v17
    buffer_load_dword v36, v36, s[60:63], 0 offen
    s_mov_b32 s60, s30
    s_and_b32 s61, s31, 0xffff
    s_mov_b32 s62, 2752
    s_mov_b32 s63, 0x20000
    v_lshlrev_b32 v38, 1, v33
    s_lshl_b32 s10, s76, 6
Lhop_1:
    s_cbranch_execz Lhop_2
    buffer_load_ushort v38, v38, s[60:63], s10 offen
    s_mov_b32 s60, s34
    s_and_b32 s61, s35, 0xffff
    s_mov_b32 s62, 1024
    s_mov_b32 s63, 0x20000
    buffer_load_ushort v19, v35, s[60:63], 0 offen
L_nomlpw:
    s_mov_b32 s73, 0x05040100
    s_mov_b32 s74, 0x07060302
    v_mov_b32 v9, s47
    s_lshl_b32 s10, s9, 2
    v_lshlrev_b32 v16, 4, v1
    v_lshrrev_b32 v14, 4, v0
    v_lshlrev_b32 v14, 3, v14
    v_lshl_add_u32 v14, v3, 1, v14
    v_and_b32 v2, 8, v0
    v_lshl_add_u32 v191, v2, 21, v14
    v_lshl_add_u32 v14, v2, 10, v14
    v_lshl_add_u32 v16, v15, 7, v16
    v_add_u32 v16, s10, v16
    s_waitcnt vmcnt(0)
    v_perm_b32 v192, v68, v64, s73
    v_perm_b32 v193, v68, v64, s74
    v_perm_b32 v194, v69, v65, s73
    v_perm_b32 v195, v69, v65, s74
    v_perm_b32 v196, v70, v66, s73
    v_perm_b32 v197, v70, v66, s74
    v_perm_b32 v198, v71, v67, s73
    v_perm_b32 v199, v71, v67, s74
    v_perm_b32 v200, v76, v72, s73
    v_perm_b32 v201, v76, v72, s74
    v_perm_b32 v202, v77, v73, s73
    v_perm_b32 v203, v77, v73, s74
    v_perm_b32 v204, v78, v74, s73
    v_perm_b32 v205, v78, v74, s74
    v_perm_b32 v206, v79, v75, s73
    v_perm_b32 v207, v79, v75, s74
    v_perm_b32 v208, v84, v80, s73
    v_perm_b32 v209, v84, v80, s74
    v_perm_b32 v210, v85, v81, s73
    v_perm_b32 v211, v85, v81, s74
    v_perm_b32 v212, v86, v82, s73
    v_perm_b32 v213, v86, v82, s74
    v_perm_b32 v214, v87, v83, s73
    v_perm_b32 v215, v87, v83, s74
    v_perm_b32 v216, v92, v88, s73
    v_perm_b32 v217, v92, v88, s74
    v_perm_b32 v218, v93, v89, s73
    v_perm_b32 v219, v93, v89, s74
    v_perm_b32 v220, v94, v90, s73
    v_perm_b32 v221, v94, v90, s74
    v_perm_b32 v222, v95, v91, s73
    v_perm_b32 v223, v95, v91, s74
    v_perm_b32 v224, v100, v96, s73
    v_perm_b32 v225, v100, v96, s74
    v_perm_b32 v226, v101, v97, s73
    v_perm_b32 v227, v101, v97, s74
    v_perm_b32 v228, v102, v98, s73
    v_perm_b32 v229, v102, v98, s74
    v_perm_b32 v230, v103, v99, s73
    v_perm_b32 v231, v103, v99, s74
Lhop_2:
    s_cbranch_execz Lhop_3
    v_perm_b32 v232, v108, v104, s73
    v_perm_b32 v233, v108, v104, s74
    v_perm_b32 v234, v109, v105, s73
    v_perm_b32 v235, v109, v105, s74
    v_perm_b32 v236, v110, v106, s73
    v_perm_b32 v237, v110, v106, s74
    v_perm_b32 v238, v111, v107, s73
    v_perm_b32 v239, v111, v107, s74
    v_perm_b32 v240, v116, v112, s73
    v_perm_b32 v241, v116, v112, s74
    v_perm_b32 v242, v117, v113, s73
    v_perm_b32 v243, v117, v113, s74
    v_perm_b32 v244, v118, v114, s73
    v_perm_b32 v245, v118, v114, s74
    v_perm_b32 v246, v119, v115, s73
    v_perm_b32 v247, v119, v115, s74
    v_perm_b32 v248, v124, v120, s73
    v_perm_b32 v249, v124, v120, s74
    v_perm_b32 v250, v125, v121, s73
    v_perm_b32 v251, v125, v121, s74
    v_perm_b32 v252, v126, v122, s73
    v_perm_b32 v253, v126, v122, s74
    v_perm_b32 v254, v127, v123, s73
    v_perm_b32 v255, v127, v123, s74
    s_cmp_eq_u32 s77, 0
    s_cbranch_scc1 L_nopair
    v_perm_b32 v64, v132, v128, s73
    v_perm_b32 v65, v132, v128, s74
    v_perm_b32 v66, v133, v129, s73
    v_perm_b32 v67, v133, v129, s74
    v_perm_b32 v68, v134, v130, s73
    v_perm_b32 v69, v134, v130, s74
    v_perm_b32 v70, v135, v131, s73
    v_perm_b32 v71, v135, v131, s74
    v_perm_b32 v72, v140, v136, s73
    v_perm_b32 v73, v140, v136, s74
    v_perm_b32 v74, v141, v137, s73
    v_perm_b32 v75, v141, v137, s74
    v_perm_b32 v76, v142, v138, s73
    v_perm_b32 v77, v142, v138, s74
    v_perm_b32 v78, v143, v139, s73
    v_perm_b32 v79, v143, v139, s74
    v_perm_b32 v80, v148, v144, s73
    v_perm_b32 v81, v148, v144, s74
    v_perm_b32 v82, v149, v145, s73
    v_perm_b32 v83, v149, v145, s74
    v_perm_b32 v84, v150, v146, s73
    v_perm_b32 v85, v150, v146, s74
    v_perm_b32 v86, v151, v147, s73
    v_perm_b32 v87, v151, v147, s74
    v_perm_b32 v88, v156, v152, s73
    v_perm_b32 v89, v156, v152, s74
    v_perm_b32 v90, v157, v153, s73
    v_perm_b32 v91, v157, v153, s74
    v_perm_b32 v92, v158, v154, s73
    v_perm_b32 v93, v158, v154, s74
Lhop_3:
    s_cbranch_execz Lhop_4
    v_perm_b32 v94, v159, v155, s73
    v_perm_b32 v95, v159, v155, s74
    v_and_b32 v37, 0xffff0000, v36
    v_lshlrev_b32 v36, 16, v36
    v_lshlrev_b32 v38, 16, v38
    v_lshlrev_b32 v19, 16, v19
    s_mov_b32 s10, 20480
    s_mov_b32 s11, 24576
    s_mov_b32 s12, 28672
    s_mov_b32 s13, 32768
    s_mov_b32 s15, 0
    s_branch Lpoll_10
Lretry_11:
    s_add_u32 s15, s15, 1
    s_cmp_gt_u32 s15, 2000000
    s_cbranch_scc1 Ldone_12
    s_sleep 8
Lpoll_10:
    buffer_load_dwordx2 v[40:41], v23, s[48:51], s10 offen sc1
    buffer_load_dwordx2 v[42:43], v23, s[48:51], s10 offen offset:2048 sc1
    buffer_load_dwordx2 v[44:45], v23, s[48:51], s11 offen sc1
    buffer_load_dword v46, v34, s[48:51], s11 offen offset:2048 sc1
    buffer_load_dwordx2 v[48:49], v23, s[48:51], s12 offen sc1
    buffer_load_dwordx2 v[50:51], v23, s[48:51], s12 offen offset:2048 sc1
    buffer_load_dwordx2 v[52:53], v23, s[48:51], s13 offen sc1
    buffer_load_dword v54, v34, s[48:51], s13 offen offset:2048 sc1
    s_waitcnt vmcnt(0)
    v_xor_b32 v40, s47, v40
    v_xor_b32 v41, s47, v41
    v_xor_b32 v42, s47, v42
    v_xor_b32 v43, s47, v43
    v_xor_b32 v44, s47, v44
    v_xor_b32 v45, s47, v45
    v_xor_b32 v46, s47, v46
    v_xor_b32 v48, s47, v48
    v_xor_b32 v49, s47, v49
    v_xor_b32 v50, s47, v50
    v_xor_b32 v51, s47, v51
    v_xor_b32 v52, s47, v52
    v_xor_b32 v53, s47, v53
    v_xor_b32 v54, s47, v54
    v_or3_b32 v10, v40, v41, v42
    v_or3_b32 v11, v48, v49, v50
    v_or3_b32 v10, v10, v43, v44
    v_or3_b32 v11, v11, v51, v52
    v_or3_b32 v10, v10, v45, v46
    v_or3_b32 v11, v11, v53, v54
    v_or_b32 v10, v10, v11
    v_and_b32 v10, 0xff, v10
    v_cmp_ne_u32 vcc, 0, v10
    s_cbranch_vccnz Lretry_11
Ldone_12:
    v_add_f32 v40, v40, v48
    v_add_f32 v41, v41, v49
    v_add_f32 v42, v42, v50
    v_add_f32 v43, v43, v51
    v_add_f32 v44, v44, v52
    v_add_f32 v45, v45, v53
    v_add_f32 v46, v46, v54
    v_cvt_pk_bf16_f32 v24, 0, v40
    v_cvt_pk_bf16_f32 v25, 0, v41
    v_cvt_pk_bf16_f32 v28, 0, v42
    v_cvt_pk_bf16_f32 v29, 0, v43
    v_cvt_pk_bf16_f32 v26, 0, v44
    v_cvt_pk_bf16_f32 v27, 0, v45
    v_cvt_pk_bf16_f32 v30, 0, v46
    v_add_f32 v26, 1.0, v26
    v_add_f32 v27, 1.0, v27
    v_cvt_pk_bf16_f32 v26, 0, v26
    v_cvt_pk_bf16_f32 v27, 0, v27
    v_mov_b32 v128, 0
    v_mov_b32 v129, 0
    v_mov_b32 v130, 0
    v_mov_b32 v131, 0
    v_mov_b32 v132, 0
    v_mov_b32 v133, 0
    v_mov_b32 v134, 0
    v_mov_b32 v135, 0
    v_mov_b32 v136, 0
    v_mov_b32 v137, 0
    v_mov_b32 v138, 0
    v_mov_b32 v139, 0
Lhop_4:
    s_cbranch_execz Lhop_5
    v_mov_b32 v140, 0
    v_mov_b32 v141, 0
    v_mov_b32 v142, 0
    v_mov_b32 v143, 0
    v_mov_b32 v144, 0
    v_mov_b32 v145, 0
    v_mov_b32 v146, 0
    v_mov_b32 v147, 0
    v_mov_b32 v148, 0
    v_mov_b32 v149, 0
    v_mov_b32 v150, 0
    v_mov_b32 v151, 0
    v_mov_b32 v10, 0x3f803f80
    v_cvt_pk_bf16_f32 v11, v28, v29
    s_nop 0
    v_dot2c_f32_bf16_dpp v128, v10, v64 quad_perm:[0,0,0,0] row_mask:0xf bank_mask:0xf
    v_dot2c_f32_bf16_dpp v129, v10, v65 quad_perm:[0,0,0,0] row_mask:0xf bank_mask:0xf
    v_dot2c_f32_bf16_dpp v130, v10, v66 quad_perm:[0,0,0,0] row_mask:0xf bank_mask:0xf
    v_dot2c_f32_bf16_dpp v131, v10, v67 quad_perm:[0,0,0,0] row_mask:0xf bank_mask:0xf
    v_dot2c_f32_bf16_dpp v132, v10, v68 quad_perm:[0,0,0,0] row_mask:0xf bank_mask:0xf
    v_dot2c_f32_bf16_dpp v133, v10, v69 quad_perm:[0,0,0,0] row_mask:0xf bank_mask:0xf
    v_dot2c_f32_bf16_dpp v134, v10, v70 quad_perm:[0,0,0,0] row_mask:0xf bank_mask:0xf
    v_dot2c_f32_bf16_dpp v135, v10, v71 quad_perm:[0,0,0,0] row_mask:0xf bank_mask:0xf
    v_dot2c_f32_bf16_dpp v128, v10, v72 quad_perm:[1,1,1,1] row_mask:0xf bank_mask:0xf
    v_dot2c_f32_bf16_dpp v129, v10, v73 quad_perm:[1,1,1,1] row_mask:0xf bank_mask:0xf
    v_dot2c_f32_bf16_dpp v130, v10, v74 quad_perm:[1,1,1,1] row_mask:0xf bank_mask:0xf
    v_dot2c_f32_bf16_dpp v131, v10, v75 quad_perm:[1,1,1,1] row_mask:0xf bank_mask:0xf
    v_dot2c_f32_bf16_dpp v132, v10, v76 quad_perm:[1,1,1,1] row_mask:0xf bank_mask:0xf
    v_dot2c_f32_bf16_dpp v133, v10, v77 quad_perm:[1,1,1,1] row_mask:0xf bank_mask:0xf
    v_dot2c_f32_bf16_dpp v134, v10, v78 quad_perm:[1,1,1,1] row_mask:0xf bank_mask:0xf
    v_dot2c_f32_bf16_dpp v135, v10, v79 quad_perm:[1,1,1,1] row_mask:0xf bank_mask:0xf
    v_dot2c_f32_bf16_dpp v128, v10, v80 quad_perm:[2,2,2,2] row_mask:0xf bank_mask:0xf
    v_dot2c_f32_bf16_dpp v129, v10, v81 quad_perm:[2,2,2,2] row_mask:0xf bank_mask:0xf
    v_dot2c_f32_bf16_dpp v130, v10, v82 quad_perm:[2,2,2,2] row_mask:0xf bank_mask:0xf
    v_dot2c_f32_bf16_dpp v131, v10, v83 quad_perm:[2,2,2,2] row_mask:0xf bank_mask:0xf
    v_dot2c_f32_bf16_dpp v132, v10, v84 quad_perm:[2,2,2,2] row_mask:0xf bank_mask:0xf
    v_dot2c_f32_bf16_dpp v133, v10, v85 quad_perm:[2,2,2,2] row_mask:0xf bank_mask:0xf
    v_dot2c_f32_bf16_dpp v134, v10, v86 quad_perm:[2,2,2,2] row_mask:0xf bank_mask:0xf
    v_dot2c_f32_bf16_dpp v135, v10, v87 quad_perm:[2,2,2,2] row_mask:0xf bank_mask:0xf
    v_dot2c_f32_bf16_dpp v128, v10, v88 quad_perm:[3,3,3,3] row_mask:0xf bank_mask:0xf
    v_dot2c_f32_bf16_dpp v129, v10, v89 quad_perm:[3,3,3,3] row_mask:0xf bank_mask:0xf
    v_dot2c_f32_bf16_dpp v130, v10, v90 quad_perm:[3,3,3,3] row_mask:0xf bank_mask:0xf
    v_dot2c_f32_bf16_dpp v131, v10, v91 quad_perm:[3,3,3,3] row_mask:0xf bank_mask:0xf
    v_dot2c_f32_bf16_dpp v132, v10, v92 quad_perm:[3,3,3,3] row_mask:0xf bank_mask:0xf
    v_dot2c_f32_bf16_dpp v133, v10, v93 quad_perm:[3,3,3,3] row_mask:0xf bank_mask:0xf
    v_dot2c_f32_bf16_dpp v134, v10, v94 quad_perm:[3,3,3,3] row_mask:0xf bank_mask:0xf
    v_dot2c_f32_bf16_dpp v135, v10, v95 quad_perm:[3,3,3,3] row_mask:0xf bank_mask:0xf
    v_dot2c_f32_bf16_dpp v136, v11, v64 quad_perm:[0,0,0,0] row_mask:0xf bank_mask:0xf
    v_dot2c_f32_bf16_dpp v137, v11, v65 quad_perm:[0,0,0,0] row_mask:0xf bank_mask:0xf
    v_dot2c_f32_bf16_dpp v138, v11, v66 quad_perm:[0,0,0,0] row_mask:0xf bank_mask:0xf
    v_dot2c_f32_bf16_dpp v139, v11, v67 quad_perm:[0,0,0,0] row_mask:0xf bank_mask:0xf
    v_dot2c_f32_bf16_dpp v140, v11, v68 quad_perm:[0,0,0,0] row_mask:0xf bank_mask:0xf
    v_dot2c_f32_bf16_dpp v141, v11, v69 quad_perm:[0,0,0,0] row_mask:0xf bank_mask:0xf
    v_dot2c_f32_bf16_dpp v142, v11, v70 quad_perm:[0,0,0,0] row_mask:0xf bank_mask:0xf
    v_dot2c_f32_bf16_dpp v143, v11, v71 quad_perm:[0,0,0,0] row_mask:0xf bank_mask:0xf
    v_dot2c_f32_bf16_dpp v136, v11, v72 quad_perm:[1,1,1,1] row_mask:0xf bank_mask:0xf
    v_dot2c_f32_bf16_dpp v137, v11, v73 quad_perm:[1,1,1,1] row_mask:0xf bank_mask:0xf
    v_dot2c_f32_bf16_dpp v138, v11, v74 quad_perm:[1,1,1,1] row_mask:0xf bank_mask:0xf
    v_dot2c_f32_bf16_dpp v139, v11, v75 quad_perm:[1,1,1,1] row_mask:0xf bank_mask:0xf
    v_dot2c_f32_bf16_dpp v140, v11, v76 quad_perm:[1,1,1,1] row_mask:0xf bank_mask:0xf
    v_dot2c_f32_bf16_dpp v141, v11, v77 quad_perm:[1,1,1,1] row_mask:0xf bank_mask:0xf
    v_dot2c_f32_bf16_dpp v142, v11, v78 quad_perm:[1,1,1,1] row_mask:0xf bank_mask:0xf
Lhop_5:
    s_cbranch_execz L_warmdonet
    v_dot2c_f32_bf16_dpp v143, v11, v79 quad_perm:[1,1,1,1] row_mask:0xf bank_mask:0xf
    v_dot2c_f32_bf16_dpp v136, v11, v80 quad_perm:[2,2,2,2] row_mask:0xf bank_mask:0xf
    v_dot2c_f32_bf16_dpp v137, v11, v81 quad_perm:[2,2,2,2] row_mask:0xf bank_mask:0xf
    v_dot2c_f32_bf16_dpp v138, v11, v82 quad_perm:[2,2,2,2] row_mask:0xf bank_mask:0xf
    v_dot2c_f32_bf16_dpp v139, v11, v83 quad_perm:[2,2,2,2] row_mask:0xf bank_mask:0xf
    v_dot2c_f32_bf16_dpp v140, v11, v84 quad_perm:[2,2,2,2] row_mask:0xf bank_mask:0xf
    v_dot2c_f32_bf16_dpp v141, v11, v85 quad_perm:[2,2,2,2] row_mask:0xf bank_mask:0xf
    v_dot2c_f32_bf16_dpp v142, v11, v86 quad_perm:[2,2,2,2] row_mask:0xf bank_mask:0xf
    v_dot2c_f32_bf16_dpp v143, v11, v87 quad_perm:[2,2,2,2] row_mask:0xf bank_mask:0xf
    v_dot2c_f32_bf16_dpp v136, v11, v88 quad_perm:[3,3,3,3] row_mask:0xf bank_mask:0xf
    v_dot2c_f32_bf16_dpp v137, v11, v89 quad_perm:[3,3,3,3] row_mask:0xf bank_mask:0xf
    v_dot2c_f32_bf16_dpp v138, v11, v90 quad_perm:[3,3,3,3] row_mask:0xf bank_mask:0xf
    v_dot2c_f32_bf16_dpp v139, v11, v91 quad_perm:[3,3,3,3] row_mask:0xf bank_mask:0xf
    v_dot2c_f32_bf16_dpp v140, v11, v92 quad_perm:[3,3,3,3] row_mask:0xf bank_mask:0xf
    v_dot2c_f32_bf16_dpp v141, v11, v93 quad_perm:[3,3,3,3] row_mask:0xf bank_mask:0xf
    v_dot2c_f32_bf16_dpp v142, v11, v94 quad_perm:[3,3,3,3] row_mask:0xf bank_mask:0xf
    v_dot2c_f32_bf16_dpp v143, v11, v95 quad_perm:[3,3,3,3] row_mask:0xf bank_mask:0xf
    v_lshlrev_b32 v40, 16, v64
    v_and_b32 v41, 0xffff0000, v64
    v_lshlrev_b32 v42, 16, v65
    v_and_b32 v43, 0xffff0000, v65
    v_mul_f32_dpp v40, v26, v40 quad_perm:[0,0,0,0] row_mask:0xf bank_mask:0xf
    v_mul_f32_dpp v41, v27, v41 quad_perm:[0,0,0,0] row_mask:0xf bank_mask:0xf
    v_mul_f32_dpp v42, v26, v42 quad_perm:[0,0,0,0] row_mask:0xf bank_mask:0xf
    v_mul_f32_dpp v43, v27, v43 quad_perm:[0,0,0,0] row_mask:0xf bank_mask:0xf
    v_cvt_pk_bf16_f32 v64, v40, v41
    v_cvt_pk_bf16_f32 v65, v42, v43
    v_lshlrev_b32 v40, 16, v66
    v_and_b32 v41, 0xffff0000, v66
    v_lshlrev_b32 v42, 16, v67
    v_and_b32 v43, 0xffff0000, v67
    v_mul_f32_dpp v40, v26, v40 quad_perm:[0,0,0,0] row_mask:0xf bank_mask:0xf
    v_mul_f32_dpp v41, v27, v41 quad_perm:[0,0,0,0] row_mask:0xf bank_mask:0xf
    v_mul_f32_dpp v42, v26, v42 quad_perm:[0,0,0,0] row_mask:0xf bank_mask:0xf
    v_mul_f32_dpp v43, v27, v43 quad_perm:[0,0,0,0] row_mask:0xf bank_mask:0xf
    v_cvt_pk_bf16_f32 v66, v40, v41
    v_cvt_pk_bf16_f32 v67, v42, v43
    v_lshlrev_b32 v40, 16, v68
    v_and_b32 v41, 0xffff0000, v68
    v_lshlrev_b32 v42, 16, v69
    v_and_b32 v43, 0xffff0000, v69
    v_mul_f32_dpp v40, v26, v40 quad_perm:[0,0,0,0] row_mask:0xf bank_mask:0xf
    v_mul_f32_dpp v41, v27, v41 quad_perm:[0,0,0,0] row_mask:0xf bank_mask:0xf
    v_mul_f32_dpp v42, v26, v42 quad_perm:[0,0,0,0] row_mask:0xf bank_mask:0xf
    v_mul_f32_dpp v43, v27, v43 quad_perm:[0,0,0,0] row_mask:0xf bank_mask:0xf
    v_cvt_pk_bf16_f32 v68, v40, v41
    v_cvt_pk_bf16_f32 v69, v42, v43
    v_lshlrev_b32 v40, 16, v70
    v_and_b32 v41, 0xffff0000, v70
    v_lshlrev_b32 v42, 16, v71
    v_and_b32 v43, 0xffff0000, v71
    v_mul_f32_dpp v40, v26, v40 quad_perm:[0,0,0,0] row_mask:0xf bank_mask:0xf
    v_mul_f32_dpp v41, v27, v41 quad_perm:[0,0,0,0] row_mask:0xf bank_mask:0xf
    v_mul_f32_dpp v42, v26, v42 quad_perm:[0,0,0,0] row_mask:0xf bank_mask:0xf
    v_mul_f32_dpp v43, v27, v43 quad_perm:[0,0,0,0] row_mask:0xf bank_mask:0xf
    v_cvt_pk_bf16_f32 v70, v40, v41
    v_cvt_pk_bf16_f32 v71, v42, v43
    v_lshlrev_b32 v40, 16, v72
    v_and_b32 v41, 0xffff0000, v72
    v_lshlrev_b32 v42, 16, v73
Lhop_6:
    s_cbranch_execz Lhop_7
    v_and_b32 v43, 0xffff0000, v73
    v_mul_f32_dpp v40, v26, v40 quad_perm:[1,1,1,1] row_mask:0xf bank_mask:0xf
    v_mul_f32_dpp v41, v27, v41 quad_perm:[1,1,1,1] row_mask:0xf bank_mask:0xf
    v_mul_f32_dpp v42, v26, v42 quad_perm:[1,1,1,1] row_mask:0xf bank_mask:0xf
    v_mul_f32_dpp v43, v27, v43 quad_perm:[1,1,1,1] row_mask:0xf bank_mask:0xf
    v_cvt_pk_bf16_f32 v72, v40, v41
    v_cvt_pk_bf16_f32 v73, v42, v43
    v_lshlrev_b32 v40, 16, v74
    v_and_b32 v41, 0xffff0000, v74
    v_lshlrev_b32 v42, 16, v75
    v_and_b32 v43, 0xffff0000, v75
    v_mul_f32_dpp v40, v26, v40 quad_perm:[1,1,1,1] row_mask:0xf bank_mask:0xf
    v_mul_f32_dpp v41, v27, v41 quad_perm:[1,1,1,1] row_mask:0xf bank_mask:0xf
    v_mul_f32_dpp v42, v26, v42 quad_perm:[1,1,1,1] row_mask:0xf bank_mask:0xf
    v_mul_f32_dpp v43, v27, v43 quad_perm:[1,1,1,1] row_mask:0xf bank_mask:0xf
    v_cvt_pk_bf16_f32 v74, v40, v41
    v_cvt_pk_bf16_f32 v75, v42, v43
    v_lshlrev_b32 v40, 16, v76
    v_and_b32 v41, 0xffff0000, v76
    v_lshlrev_b32 v42, 16, v77
    v_and_b32 v43, 0xffff0000, v77
    v_mul_f32_dpp v40, v26, v40 quad_perm:[1,1,1,1] row_mask:0xf bank_mask:0xf
    v_mul_f32_dpp v41, v27, v41 quad_perm:[1,1,1,1] row_mask:0xf bank_mask:0xf
    v_mul_f32_dpp v42, v26, v42 quad_perm:[1,1,1,1] row_mask:0xf bank_mask:0xf
    v_mul_f32_dpp v43, v27, v43 quad_perm:[1,1,1,1] row_mask:0xf bank_mask:0xf
    v_cvt_pk_bf16_f32 v76, v40, v41
    v_cvt_pk_bf16_f32 v77, v42, v43
    v_lshlrev_b32 v40, 16, v78
    v_and_b32 v41, 0xffff0000, v78
    v_lshlrev_b32 v42, 16, v79
    v_and_b32 v43, 0xffff0000, v79
    v_mul_f32_dpp v40, v26, v40 quad_perm:[1,1,1,1] row_mask:0xf bank_mask:0xf
    v_mul_f32_dpp v41, v27, v41 quad_perm:[1,1,1,1] row_mask:0xf bank_mask:0xf
    v_mul_f32_dpp v42, v26, v42 quad_perm:[1,1,1,1] row_mask:0xf bank_mask:0xf
    v_mul_f32_dpp v43, v27, v43 quad_perm:[1,1,1,1] row_mask:0xf bank_mask:0xf
    v_cvt_pk_bf16_f32 v78, v40, v41
    v_cvt_pk_bf16_f32 v79, v42, v43
    v_lshlrev_b32 v40, 16, v80
    v_and_b32 v41, 0xffff0000, v80
    v_lshlrev_b32 v42, 16, v81
    v_and_b32 v43, 0xffff0000, v81
    v_mul_f32_dpp v40, v26, v40 quad_perm:[2,2,2,2] row_mask:0xf bank_mask:0xf
    v_mul_f32_dpp v41, v27, v41 quad_perm:[2,2,2,2] row_mask:0xf bank_mask:0xf
    v_mul_f32_dpp v42, v26, v42 quad_perm:[2,2,2,2] row_mask:0xf bank_mask:0xf
    v_mul_f32_dpp v43, v27, v43 quad_perm:[2,2,2,2] row_mask:0xf bank_mask:0xf
    v_cvt_pk_bf16_f32 v80, v40, v41
    v_cvt_pk_bf16_f32 v81, v42, v43
    v_lshlrev_b32 v40, 16, v82
    v_and_b32 v41, 0xffff0000, v82
    v_lshlrev_b32 v42, 16, v83
    v_and_b32 v43, 0xffff0000, v83
    v_mul_f32_dpp v40, v26, v40 quad_perm:[2,2,2,2] row_mask:0xf bank_mask:0xf
    v_mul_f32_dpp v41, v27, v41 quad_perm:[2,2,2,2] row_mask:0xf bank_mask:0xf
    v_mul_f32_dpp v42, v26, v42 quad_perm:[2,2,2,2] row_mask:0xf bank_mask:0xf
    v_mul_f32_dpp v43, v27, v43 quad_perm:[2,2,2,2] row_mask:0xf bank_mask:0xf
    v_cvt_pk_bf16_f32 v82, v40, v41
    v_cvt_pk_bf16_f32 v83, v42, v43
    v_lshlrev_b32 v40, 16, v84
    v_and_b32 v41, 0xffff0000, v84
    v_lshlrev_b32 v42, 16, v85
    v_and_b32 v43, 0xffff0000, v85
Lhop_7:
    s_cbranch_execz Lhop_8
    v_mul_f32_dpp v40, v26, v40 quad_perm:[2,2,2,2] row_mask:0xf bank_mask:0xf
    v_mul_f32_dpp v41, v27, v41 quad_perm:[2,2,2,2] row_mask:0xf bank_mask:0xf
    v_mul_f32_dpp v42, v26, v42 quad_perm:[2,2,2,2] row_mask:0xf bank_mask:0xf
    v_mul_f32_dpp v43, v27, v43 quad_perm:[2,2,2,2] row_mask:0xf bank_mask:0xf
    v_cvt_pk_bf16_f32 v84, v40, v41
    v_cvt_pk_bf16_f32 v85, v42, v43
    v_lshlrev_b32 v40, 16, v86
    v_and_b32 v41, 0xffff0000, v86
    v_lshlrev_b32 v42, 16, v87
    v_and_b32 v43, 0xffff0000, v87
    v_mul_f32_dpp v40, v26, v40 quad_perm:[2,2,2,2] row_mask:0xf bank_mask:0xf
    v_mul_f32_dpp v41, v27, v41 quad_perm:[2,2,2,2] row_mask:0xf bank_mask:0xf
    v_mul_f32_dpp v42, v26, v42 quad_perm:[2,2,2,2] row_mask:0xf bank_mask:0xf
    v_mul_f32_dpp v43, v27, v43 quad_perm:[2,2,2,2] row_mask:0xf bank_mask:0xf
    v_cvt_pk_bf16_f32 v86, v40, v41
    v_cvt_pk_bf16_f32 v87, v42, v43
    v_lshlrev_b32 v40, 16, v88
    v_and_b32 v41, 0xffff0000, v88
    v_lshlrev_b32 v42, 16, v89
    v_and_b32 v43, 0xffff0000, v89
    v_mul_f32_dpp v40, v26, v40 quad_perm:[3,3,3,3] row_mask:0xf bank_mask:0xf
    v_mul_f32_dpp v41, v27, v41 quad_perm:[3,3,3,3] row_mask:0xf bank_mask:0xf
    v_mul_f32_dpp v42, v26, v42 quad_perm:[3,3,3,3] row_mask:0xf bank_mask:0xf
    v_mul_f32_dpp v43, v27, v43 quad_perm:[3,3,3,3] row_mask:0xf bank_mask:0xf
    v_cvt_pk_bf16_f32 v88, v40, v41
    v_cvt_pk_bf16_f32 v89, v42, v43
    v_lshlrev_b32 v40, 16, v90
    v_and_b32 v41, 0xffff0000, v90
    v_lshlrev_b32 v42, 16, v91
    v_and_b32 v43, 0xffff0000, v91
    v_mul_f32_dpp v40, v26, v40 quad_perm:[3,3,3,3] row_mask:0xf bank_mask:0xf
    v_mul_f32_dpp v41, v27, v41 quad_perm:[3,3,3,3] row_mask:0xf bank_mask:0xf
    v_mul_f32_dpp v42, v26, v42 quad_perm:[3,3,3,3] row_mask:0xf bank_mask:0xf
    v_mul_f32_dpp v43, v27, v43 quad_perm:[3,3,3,3] row_mask:0xf bank_mask:0xf
    v_cvt_pk_bf16_f32 v90, v40, v41
    v_cvt_pk_bf16_f32 v91, v42, v43
    v_lshlrev_b32 v40, 16, v92
    v_and_b32 v41, 0xffff0000, v92
    v_lshlrev_b32 v42, 16, v93
    v_and_b32 v43, 0xffff0000, v93
    v_mul_f32_dpp v40, v26, v40 quad_perm:[3,3,3,3] row_mask:0xf bank_mask:0xf
    v_mul_f32_dpp v41, v27, v41 quad_perm:[3,3,3,3] row_mask:0xf bank_mask:0xf
    v_mul_f32_dpp v42, v26, v42 quad_perm:[3,3,3,3] row_mask:0xf bank_mask:0xf
    v_mul_f32_dpp v43, v27, v43 quad_perm:[3,3,3,3] row_mask:0xf bank_mask:0xf
    v_cvt_pk_bf16_f32 v92, v40, v41
    v_cvt_pk_bf16_f32 v93, v42, v43
    v_lshlrev_b32 v40, 16, v94
    v_and_b32 v41, 0xffff0000, v94
    v_lshlrev_b32 v42, 16, v95
    v_and_b32 v43, 0xffff0000, v95
    v_mul_f32_dpp v40, v26, v40 quad_perm:[3,3,3,3] row_mask:0xf bank_mask:0xf
    v_mul_f32_dpp v41, v27, v41 quad_perm:[3,3,3,3] row_mask:0xf bank_mask:0xf
    v_mul_f32_dpp v42, v26, v42 quad_perm:[3,3,3,3] row_mask:0xf bank_mask:0xf
    v_mul_f32_dpp v43, v27, v43 quad_perm:[3,3,3,3] row_mask:0xf bank_mask:0xf
    v_cvt_pk_bf16_f32 v94, v40, v41
    v_cvt_pk_bf16_f32 v95, v42, v43
    v_dot2c_f32_bf16_dpp v144, v10, v64 quad_perm:[0,0,0,0] row_mask:0xf bank_mask:0xf
    v_dot2c_f32_bf16_dpp v145, v10, v65 quad_perm:[0,0,0,0] row_mask:0xf bank_mask:0xf
    v_dot2c_f32_bf16_dpp v146, v10, v66 quad_perm:[0,0,0,0] row_mask:0xf bank_mask:0xf
    v_dot2c_f32_bf16_dpp v147, v10, v67 quad_perm:[0,0,0,0] row_mask:0xf bank_mask:0xf
Lhop_8:
    s_cbranch_execz Lhop_9
    v_dot2c_f32_bf16_dpp v148, v10, v68 quad_perm:[0,0,0,0] row_mask:0xf bank_mask:0xf
    v_dot2c_f32_bf16_dpp v149, v10, v69 quad_perm:[0,0,0,0] row_mask:0xf bank_mask:0xf
    v_dot2c_f32_bf16_dpp v150, v10, v70 quad_perm:[0,0,0,0] row_mask:0xf bank_mask:0xf
    v_dot2c_f32_bf16_dpp v151, v10, v71 quad_perm:[0,0,0,0] row_mask:0xf bank_mask:0xf
    v_dot2c_f32_bf16_dpp v144, v10, v72 quad_perm:[1,1,1,1] row_mask:0xf bank_mask:0xf
    v_dot2c_f32_bf16_dpp v145, v10, v73 quad_perm:[1,1,1,1] row_mask:0xf bank_mask:0xf
    v_dot2c_f32_bf16_dpp v146, v10, v74 quad_perm:[1,1,1,1] row_mask:0xf bank_mask:0xf
    v_dot2c_f32_bf16_dpp v147, v10, v75 quad_perm:[1,1,1,1] row_mask:0xf bank_mask:0xf
    v_dot2c_f32_bf16_dpp v148, v10, v76 quad_perm:[1,1,1,1] row_mask:0xf bank_mask:0xf
    v_dot2c_f32_bf16_dpp v149, v10, v77 quad_perm:[1,1,1,1] row_mask:0xf bank_mask:0xf
    v_dot2c_f32_bf16_dpp v150, v10, v78 quad_perm:[1,1,1,1] row_mask:0xf bank_mask:0xf
    v_dot2c_f32_bf16_dpp v151, v10, v79 quad_perm:[1,1,1,1] row_mask:0xf bank_mask:0xf
    v_dot2c_f32_bf16_dpp v144, v10, v80 quad_perm:[2,2,2,2] row_mask:0xf bank_mask:0xf
    v_dot2c_f32_bf16_dpp v145, v10, v81 quad_perm:[2,2,2,2] row_mask:0xf bank_mask:0xf
    v_dot2c_f32_bf16_dpp v146, v10, v82 quad_perm:[2,2,2,2] row_mask:0xf bank_mask:0xf
    v_dot2c_f32_bf16_dpp v147, v10, v83 quad_perm:[2,2,2,2] row_mask:0xf bank_mask:0xf
    v_dot2c_f32_bf16_dpp v148, v10, v84 quad_perm:[2,2,2,2] row_mask:0xf bank_mask:0xf
    v_dot2c_f32_bf16_dpp v149, v10, v85 quad_perm:[2,2,2,2] row_mask:0xf bank_mask:0xf
    v_dot2c_f32_bf16_dpp v150, v10, v86 quad_perm:[2,2,2,2] row_mask:0xf bank_mask:0xf
    v_dot2c_f32_bf16_dpp v151, v10, v87 quad_perm:[2,2,2,2] row_mask:0xf bank_mask:0xf
    v_dot2c_f32_bf16_dpp v144, v10, v88 quad_perm:[3,3,3,3] row_mask:0xf bank_mask:0xf
    v_dot2c_f32_bf16_dpp v145, v10, v89 quad_perm:[3,3,3,3] row_mask:0xf bank_mask:0xf
    v_dot2c_f32_bf16_dpp v146, v10, v90 quad_perm:[3,3,3,3] row_mask:0xf bank_mask:0xf
    v_dot2c_f32_bf16_dpp v147, v10, v91 quad_perm:[3,3,3,3] row_mask:0xf bank_mask:0xf
    v_dot2c_f32_bf16_dpp v148, v10, v92 quad_perm:[3,3,3,3] row_mask:0xf bank_mask:0xf
    v_dot2c_f32_bf16_dpp v149, v10, v93 quad_perm:[3,3,3,3] row_mask:0xf bank_mask:0xf
    v_dot2c_f32_bf16_dpp v150, v10, v94 quad_perm:[3,3,3,3] row_mask:0xf bank_mask:0xf
    v_dot2c_f32_bf16_dpp v151, v10, v95 quad_perm:[3,3,3,3] row_mask:0xf bank_mask:0xf
    v_permlane32_swap_b32 v128, v132
    v_permlane32_swap_b32 v129, v133
    v_permlane32_swap_b32 v130, v134
    v_permlane32_swap_b32 v131, v135
    v_add_f32 v128, v128, v132
    v_add_f32 v129, v129, v133
    v_add_f32 v130, v130, v134
    v_add_f32 v131, v131, v135
    s_nop 0
    v_permlane16_swap_b32 v128, v130
    v_permlane16_swap_b32 v129, v131
    v_add_f32 v128, v128, v130
    v_add_f32 v129, v129, v131
    s_nop 0
    v_add_f32_dpp v128, v128, v128 row_ror:8 row_mask:0xf bank_mask:0x3
    v_add_f32_dpp v128, v129, v129 row_ror:8 row_mask:0xf bank_mask:0xc
    s_nop 1
    v_add_f32_dpp v128, v128, v128 row_shl:4 row_mask:0xf bank_mask:0x5
    s_mov_b32 exec_lo, 0xf0f0f0f
    s_mov_b32 exec_hi, 0xf0f0f0f
    ds_write_b32 v16, v128 offset:16384
    s_mov_b64 exec, -1
    v_permlane32_swap_b32 v136, v140
    v_permlane32_swap_b32 v137, v141
    v_permlane32_swap_b32 v138, v142
    v_permlane32_swap_b32 v139, v143
    v_add_f32 v136, v136, v140
    v_add_f32 v137, v137, v141
    v_add_f32 v138, v138, v142
    v_add_f32 v139, v139, v143
    s_nop 0
    v_permlane16_swap_b32 v136, v138
    v_permlane16_swap_b32 v137, v139
    v_add_f32 v136, v136, v138
    v_add_f32 v137, v137, v139
    s_nop 0
    v_add_f32_dpp v136, v136, v136 row_ror:8 row_mask:0xf bank_mask:0x3
    v_add_f32_dpp v136, v137, v137 row_ror:8 row_mask:0xf bank_mask:0xc
    s_nop 1
    v_add_f32_dpp v136, v136, v136 row_shl:4 row_mask:0xf bank_mask:0x5
    s_mov_b32 exec_lo, 0xf0f0f0f
    s_mov_b32 exec_hi, 0xf0f0f0f
    ds_write_b32 v16, v136 offset:16896
Lhop_9:
    s_cbranch_execz Lhop_10
    s_mov_b64 exec, -1
    v_permlane32_swap_b32 v144, v148
    v_permlane32_swap_b32 v145, v149
    v_permlane32_swap_b32 v146, v150
    v_permlane32_swap_b32 v147, v151
    v_add_f32 v144, v144, v148
    v_add_f32 v145, v145, v149
    v_add_f32 v146, v146, v150
    v_add_f32 v147, v147, v151
    s_nop 0
    v_permlane16_swap_b32 v144, v146
    v_permlane16_swap_b32 v145, v147
    v_add_f32 v144, v144, v146
    v_add_f32 v145, v145, v147
    s_nop 0
    v_add_f32_dpp v144, v144, v144 row_ror:8 row_mask:0xf bank_mask:0x3
    v_add_f32_dpp v144, v145, v145 row_ror:8 row_mask:0xf bank_mask:0xc
    s_nop 1
    v_add_f32_dpp v144, v144, v144 row_shl:4 row_mask:0xf bank_mask:0x5
    s_mov_b32 exec_lo, 0xf0f0f0f
    s_mov_b32 exec_hi, 0xf0f0f0f
    ds_write_b32 v16, v144 offset:17408
    s_mov_b64 exec, -1
L_nopair:
    s_lshr_b32 s10, s5, 2
    s_lshl_b32 s10, s10, 14
    s_and_b32 s11, s5, 2
    s_lshl_b32 s11, s11, 11
    s_add_u32 s10, s10, s11
    s_lshl_b32 s11, s4, 9
    s_add_u32 s10, s10, s11
    s_and_b32 s11, s5, 1
    s_lshl_b32 s11, s11, 8
    s_add_u32 s10, s10, s11
    s_add_u32 s75, s10, 262144
    s_add_u32 s26, s75, 8192
    s_add_u32 s27, s10, 294912
    s_lshr_b32 s62, s9, 1
    s_lshl_b32 s62, s62, 14
    s_and_b32 s11, s9, 1
    s_lshl_b32 s11, s11, 12
    s_add_u32 s62, s62, s11
    s_lshr_b32 s63, s76, 2
    s_lshl_b32 s63, s63, 14
    s_and_b32 s11, s76, 3
    s_lshl_b32 s11, s11, 11
    s_add_u32 s63, s63, s11
    s_lshl_b32 s11, s9, 9
    s_add_u32 s63, s63, s11
    s_add_u32 s63, s63, 327680
    s_add_u32 s28, s63, 8192
    s_mov_b32 s56, s40
    s_and_b32 s57, s41, 0xffff
    s_mov_b32 s58, 1024
    s_mov_b32 s59, 0x20000
    s_mov_b32 s70, 0
    s_lshl_b32 s10, s9, 2
    v_lshlrev_b32 v12, 4, v1
    v_add_u32 v12, s10, v12
    v_mov_b32 v13, v3
    v_lshlrev_b32 v22, 4, v33
    v_lshlrev_b32 v18, 5, v0
    v_lshrrev_b32 v17, 4, v0
    v_lshlrev_b32 v17, 14, v17
    v_bfe_u32 v2, v0, 2, 2
    v_lshl_add_u32 v17, v2, 11, v17
    v_lshl_add_u32 v17, v15, 4, v17
    s_cmp_eq_u32 s77, 0
    s_cbranch_scc1 L_nocst
    v_mov_b32 v168, 0x3b000000
    v_mov_b32 v172, 0x3b000000
    v_mul_f32 v169, 0x3b000000, v26
    v_mul_f32 v173, v169, v26
    v_mul_f32 v170, -2.0, v173
    v_mul_f32 v171, v169, v28
    v_add_f32 v171, v171, v171
    v_mul_f32 v46, 0x3b000000, v28
    v_mul_f32 v48, v46, v28
    v_mov_b32 v174, 0x3b000000
    v_mov_b32 v178, 0x3b000000
    v_mul_f32 v175, 0x3b000000, v27
    v_mul_f32 v179, v175, v27
    v_mul_f32 v176, -2.0, v179
    v_mul_f32 v177, v175, v29
    v_add_f32 v177, v177, v177
    v_mul_f32 v47, 0x3b000000, v29
    v_mul_f32 v49, v47, v29
Lhop_10:
    s_cbranch_execz Lhop_11
    v_add_f32 v40, v169, v175
    v_add_f32 v41, v173, v179
    v_add_f32 v42, v171, v177
    v_add_f32 v43, v46, v47
    v_add_f32 v44, v48, v49
    v_mov_b32 v45, 0
    v_permlane32_swap_b32 v40, v43
    v_permlane32_swap_b32 v41, v44
    v_permlane32_swap_b32 v42, v45
    v_add_f32 v40, v40, v43
    v_add_f32 v41, v41, v44
    v_add_f32 v42, v42, v45
    v_mov_b32 v43, v42
    v_permlane16_swap_b32 v40, v41
    s_nop 0
    v_permlane16_swap_b32 v42, v43
    v_add_f32 v40, v40, v41
    v_add_f32 v42, v42, v43
    s_nop 0
    v_add_f32_dpp v40, v40, v40 row_ror:8 row_mask:0xf bank_mask:0x3
    v_add_f32_dpp v40, v42, v42 row_ror:8 row_mask:0xf bank_mask:0xc
    s_nop 1
    v_add_f32_dpp v40, v40, v40 quad_perm:[1,0,3,2] row_mask:0xf bank_mask:0xf
    s_nop 1
    v_add_f32_dpp v40, v40, v40 quad_perm:[2,3,0,1] row_mask:0xf bank_mask:0xf
    s_nop 1
    v_add_f32_dpp v40, v40, v40 row_half_mirror row_mask:0xf bank_mask:0xf
    s_mov_b32 exec_lo, 0x1010101
    s_mov_b32 exec_hi, 0x1010101
    ds_write_b32 v12, v40 offset:11264
    s_mov_b64 exec, -1
L_nocst:
    v_mov_b32 v44, -1
    v_mov_b32 v45, -1
    v_mov_b32 v46, -1
    v_mov_b32 v47, -1
    v_lshlrev_b32 v2, 4, v0
    s_lshl_b32 s10, s9, 9
    v_add_u32 v2, s10, v2
    s_mov_b32 exec_hi, 0
    ds_write_b128 v2, v[44:47] offset:12288
    v_mov_b32 v50, 0
    v_mov_b32 v51, 1
    s_mov_b64 exec, 1
    ds_add_u32 v50, v51 offset:6168
    s_mov_b64 exec, -1
    s_mov_b32 s15, 0
    v_mov_b32 v2, 0
Lspin_13:
    ds_read_b32 v3, v2 offset:6168
    s_waitcnt lgkmcnt(0)
    v_readfirstlane_b32 s14, v3
    s_add_u32 s15, s15, 1
    s_cmp_ge_u32 s14, 4
    s_cbranch_scc1 Lspd_14
    s_cmp_gt_u32 s15, 16000000
    s_cbranch_scc1 Lspd_14
    s_sleep 1
    s_branch Lspin_13
Lspd_14:
    ds_read_b128 v[40:43], v13 offset:11264
    s_waitcnt lgkmcnt(0)
    v_add_f32 v40, v40, v41
    v_add_f32 v42, v42, v43
    v_add_f32 v40, v40, v42
    s_nop 1
    v_mov_b32_dpp v180, v40 row_newbcast:0 row_mask:0xf bank_mask:0xf
    v_mov_b32_dpp v181, v40 row_newbcast:2 row_mask:0xf bank_mask:0xf
    v_mov_b32_dpp v182, v40 row_newbcast:1 row_mask:0xf bank_mask:0xf
    v_mov_b32_dpp v183, v40 row_newbcast:4 row_mask:0xf bank_mask:0xf
    v_mov_b32_dpp v184, v40 row_newbcast:6 row_mask:0xf bank_mask:0xf
    ds_read_b128 v[128:131], v22 offset:16384
    ds_read_b128 v[132:135], v22 offset:16896
    ds_read_b128 v[136:139], v22 offset:17408
    v_and_b32 v40, 1, v0
    v_lshlrev_b32 v40, 4, v40
    v_mov_b32 v41, 0xffff
    v_lshlrev_b32 v40, v40, v41
    v_bfe_u32 v41, v0, 1, 2
    v_cmp_eq_u32 vcc, 0, v41
    s_nop 1
    v_cndmask_b32 v4, 0, v40, vcc
    v_cmp_eq_u32 vcc, 1, v41
    s_nop 1
    v_cndmask_b32 v5, 0, v40, vcc
    v_cmp_eq_u32 vcc, 2, v41
    s_nop 1
    v_cndmask_b32 v6, 0, v40, vcc
Lhop_11:
    s_cbranch_execz L_warmdonet
    v_cmp_eq_u32 vcc, 3, v41
    s_nop 1
    v_cndmask_b32 v7, 0, v40, vcc
    s_mov_b32 s52, s32
    s_and_b32 s53, s33, 0xffff
    s_mov_b32 s54, 1409024
    s_mov_b32 s55, 0x20000
    v_lshrrev_b32 v2, 4, v0
    v_and_b32 v32, 15, v0
    v_lshlrev_b32 v8, 13, v2
    v_lshl_add_u32 v8, v32, 4, v8
    s_lshl_b32 s6, s76, 15
    s_lshl_b32 s10, s9, 8
    s_add_u32 s6, s6, s10
    s_add_u32 s7, s6, 4096
    v_lshlrev_b32 v32, 5, v32
    v_and_b32 v2, 16, v0
    v_add_u32 v32, v32, v2
    v_lshrrev_b32 v2, 5, v0
    v_lshl_add_u32 v32, v2, 3, v32
    s_mov_b32 s12, 0
    s_mov_b32 s13, -1
    s_waitcnt lgkmcnt(0)
    v_add_f32 v128, v128, v129
    v_add_f32 v132, v132, v133
    v_add_f32 v136, v136, v137
    v_add_f32 v130, v130, v131
    v_add_f32 v134, v134, v135
    v_add_f32 v138, v138, v139
    v_add_f32 v128, v128, v130
    v_add_f32 v132, v132, v134
    v_add_f32 v136, v136, v138
    v_mov_b32 v185, v128
    v_mov_b32 v186, v132
    v_mov_b32 v187, v136
    v_mov_b32 v40, 0
    v_mov_b32 v41, 0
    v_mov_b32 v42, 0
    v_mov_b32 v43, 0
    v_mov_b32 v44, 0
    v_mov_b32 v45, 0
    v_mov_b32 v46, 0
    v_mov_b32 v47, 0
    v_mov_b32 v48, 0
    v_mov_b32 v49, 0
    v_mov_b32 v50, 0
    v_mov_b32 v51, 0
    v_mov_b32 v52, 0
    v_mov_b32 v53, 0
    v_mov_b32 v54, 0
    v_mov_b32 v55, 0
    s_xor_b32 s10, s9, 0
    s_lshl_b32 s10, s10, 9
    v_lshl_add_u32 v163, v0, 3, s10
    s_xor_b32 s10, s9, 1
    s_lshl_b32 s10, s10, 9
    v_lshl_add_u32 v164, v0, 3, s10
    s_xor_b32 s10, s9, 2
    s_lshl_b32 s10, s10, 9
    v_lshl_add_u32 v165, v0, 3, s10
    s_xor_b32 s10, s9, 3
    s_lshl_b32 s10, s10, 9
    v_lshl_add_u32 v166, v0, 3, s10
    v_mov_b32 v167, 0
    v_add_u32 v2, 7168, v20
    s_mov_b32 s10, 0x01010101
    s_mov_b32 s11, 0x01010101
    v_cndmask_b32 v12, v2, v12, s[10:11]
    s_mov_b32 s10, 0x0f0f0f0f
    s_mov_b32 s11, 0x0f0f0f0f
    v_cndmask_b32 v190, v2, v16, s[10:11]
    v_mov_b32 v189, 0xc0135761
    s_lshl_b32 s10, s4, 2
    s_lshl_b32 s24, 15, s10
    s_not_b32 s24, s24
    s_mov_b32 s25, s24
    s_mov_b32 s29, 0
    s_cmp_eq_u32 s77, 0
    s_cbranch_scc1 L_nonear
    s_mov_b32 s15, 0
    v_mov_b32 v2, 0
Lspin_15:
    ds_read_b32 v3, v2 offset:6164
    ds_read_b128 v[56:59], v2 offset:6656
    ds_read_b128 v[60:63], v2 offset:6672
    s_waitcnt lgkmcnt(0)
    v_readfirstlane_b32 s14, v3
    s_add_u32 s15, s15, 1
    s_cmp_ge_u32 s14, 4
    s_cbranch_scc1 Lspd_16
Lhop_12:
    s_cbranch_execz Lhop_13
    s_cmp_gt_u32 s15, 16000000
    s_cbranch_scc1 Lspd_16
    s_sleep 1
    s_branch Lspin_15
Lspd_16:
    v_min3_u32 v56, v56, v58, v60
    v_min3_u32 v57, v57, v59, v61
    v_min_u32 v56, v56, v62
    v_min_u32 v57, v57, v63
    v_cmp_lt_u32 vcc, v57, v56
    s_cmp_lg_u64 vcc, 0
    s_cselect_b32 s29, 8192, 0
L_nonear:
    s_lshl_b32 s10, s78, 2
    s_add_u32 s10, s10, s29
    s_add_u32 s60, s10, 327680
    s_add_u32 s61, s60, 65536
    s_add_u32 s8, s60, 131072
    s_xor_b32 s10, s29, 8192
    s_sub_u32 s28, s28, s10
    s_add_u32 s63, s63, s10
    s_add_u32 s30, s62, 294912
    s_add_u32 s62, s62, s29
    s_add_u32 s62, s62, 262144
    s_cmp_eq_u32 s4, 0
    s_cselect_b32 s16, s30, s62
    s_cmp_eq_u32 s4, 1
    s_cselect_b32 s17, s30, s62
    s_cmp_eq_u32 s4, 2
    s_cselect_b32 s18, s30, s62
    s_cmp_eq_u32 s4, 3
    s_cselect_b32 s19, s30, s62
    s_cmp_eq_u32 s4, 4
    s_cselect_b32 s20, s30, s62
    s_cmp_eq_u32 s4, 5
    s_cselect_b32 s21, s30, s62
    s_cmp_eq_u32 s4, 6
    s_cselect_b32 s22, s30, s62
    s_cmp_eq_u32 s4, 7
    s_cselect_b32 s23, s30, s62
    s_lshl_b32 s10, s4, 2
    s_add_u32 s10, s10, s9
    s_lshl_b32 s79, s10, 12
    s_add_u32 s79, s79, 131072
    s_lshl_b32 s10, s10, 9
    s_add_u32 s10, s10, 81920
    v_and_b32 v2, 31, v0
    v_min_u32 v2, 23, v2
    v_lshlrev_b32 v2, 4, v2
    s_getreg_b32 s69, hwreg(HW_REG_XCC_ID)
    s_lshl_b32 s69, s69, 8
    s_mov_b32 s15, 0
    s_branch Lpoll_17
Lretry_18:
    s_add_u32 s15, s15, 1
    s_cmp_gt_u32 s15, 2000000
    s_cbranch_scc1 Ldone_19
    s_sleep 8
    s_and_b32 s14, s15, 3
    s_cmp_eq_u32 s14, 3
    s_cselect_b32 s14, 524288, 0
    s_andn2_b32 s10, s10, 524288
    s_or_b32 s10, s10, s14
Lpoll_17:
    buffer_load_dwordx4 v[152:155], v2, s[48:51], s10 offen sc1
    s_waitcnt vmcnt(0)
    v_xor_b32 v152, s47, v152
    v_xor_b32 v153, s47, v153
    v_xor_b32 v154, s47, v154
    v_xor_b32 v155, s47, v155
    v_or3_b32 v10, v152, v153, v154
    v_or_b32 v10, v10, v155
    v_and_b32 v10, 0xff, v10
    v_cmp_ne_u32 vcc, 0, v10
    s_cbranch_vccnz Lretry_18
Ldone_19:
    v_cmp_ne_u32 vcc, s69, v154
    v_mov_b32 v10, v152
    s_cmp_lg_u64 vcc, 0
    s_cselect_b32 s10, 524288, 0
    s_add_u32 s79, s79, s10
    v_max_f32_dpp v10, v10, v10 quad_perm:[1,0,3,2] row_mask:0xf bank_mask:0xf
    s_nop 1
    v_max_f32_dpp v10, v10, v10 quad_perm:[2,3,0,1] row_mask:0xf bank_mask:0xf
    v_mov_b32 v11, v10
    s_nop 1
    v_max_f32_dpp v11, v11, v11 row_half_mirror row_mask:0xf bank_mask:0xf
    s_nop 1
    v_max_f32_dpp v11, v11, v11 row_mirror row_mask:0xf bank_mask:0xf
Lhop_13:
    s_cbranch_execz Lhop_14
    v_mov_b32 v56, v11
    s_nop 1
    v_permlane16_swap_b32 v11, v56
    v_max_f32 v11, v11, v56
    v_sub_f32 v152, v152, v11
    v_sub_f32 v10, v10, v11
    v_mul_f32 v152, 0x3fb8aa3b, v152
    v_mul_f32 v10, 0x3fb8aa3b, v10
    v_exp_f32 v152, v152
    v_exp_f32 v10, v10
    s_mov_b32 s10, 0x00ffffff
    s_mov_b32 s11, 0x00ffffff
    v_mul_f32 v11, v152, v153
    v_cndmask_b32 v11, 0, v11, s[10:11]
    s_nop 1
    v_add_f32_dpp v11, v11, v11 quad_perm:[1,0,3,2] row_mask:0xf bank_mask:0xf
    s_nop 1
    v_add_f32_dpp v11, v11, v11 quad_perm:[2,3,0,1] row_mask:0xf bank_mask:0xf
    s_nop 1
    v_add_f32_dpp v11, v11, v11 row_half_mirror row_mask:0xf bank_mask:0xf
    s_nop 1
    v_add_f32_dpp v11, v11, v11 row_mirror row_mask:0xf bank_mask:0xf
    v_mov_b32 v56, v11
    s_nop 1
    v_permlane16_swap_b32 v11, v56
    v_add_f32 v11, v11, v56
    v_rcp_f32 v11, v11
    s_nop 0
    v_mul_f32 v10, v10, v11
    s_nop 0
    v_readlane_b32 s64, v10, 0
    v_readlane_b32 s65, v10, 4
    v_readlane_b32 s66, v10, 8
    v_readlane_b32 s67, v10, 12
    v_readlane_b32 s68, v10, 16
    v_readlane_b32 s69, v10, 20
    s_branch L_T2
.p2align 12
L_T2:
Lhop_14:
    s_cbranch_execz Lhop_15
    s_mov_b32 s15, 0
    s_branch Lq_20
Lqr_21:
    s_add_u32 s15, s15, 1
    s_cmp_gt_u32 s15, 2000000
    s_cbranch_scc1 Lqd_22
Lq_20:
    buffer_load_dwordx2 v[128:129], v21, s[48:51], s79 offen offset:0 sc1
    buffer_load_dwordx2 v[130:131], v21, s[48:51], s79 offen offset:512 sc1
    buffer_load_dwordx2 v[132:133], v21, s[48:51], s79 offen offset:1024 sc1
    buffer_load_dwordx2 v[134:135], v21, s[48:51], s79 offen offset:1536 sc1
    buffer_load_dwordx2 v[136:137], v21, s[48:51], s79 offen offset:2048 sc1
    buffer_load_dwordx2 v[138:139], v21, s[48:51], s79 offen offset:2560 sc1
    s_waitcnt vmcnt(0)
    v_xor_b32 v129, s47, v129
    v_xor_b32 v131, s47, v131
    v_xor_b32 v133, s47, v133
    v_xor_b32 v135, s47, v135
    v_xor_b32 v137, s47, v137
    v_xor_b32 v139, s47, v139
    v_or3_b32 v10, v129, v131, v133
    v_or3_b32 v10, v10, v135, v137
    v_or_b32 v10, v10, v139
    v_cmp_ne_u32_sdwa vcc, v10, v167 src0_sel:BYTE_0 src1_sel:DWORD
    s_cbranch_vccnz Lqr_21
Lqd_22:
    v_pk_mul_f32 v[160:161], v[128:129], s[64:65] op_sel:[0,0] op_sel_hi:[1,0]
    v_pk_fma_f32 v[160:161], v[130:131], s[64:65], v[160:161] op_sel:[0,1,0] op_sel_hi:[1,1,1]
    v_pk_fma_f32 v[160:161], v[132:133], s[66:67], v[160:161] op_sel:[0,0,0] op_sel_hi:[1,0,1]
    v_pk_fma_f32 v[160:161], v[134:135], s[66:67], v[160:161] op_sel:[0,1,0] op_sel_hi:[1,1,1]
    v_pk_fma_f32 v[160:161], v[136:137], s[68:69], v[160:161] op_sel:[0,0,0] op_sel_hi:[1,0,1]
    v_pk_fma_f32 v[160:161], v[138:139], s[68:69], v[160:161] op_sel:[0,1,0] op_sel_hi:[1,1,1]
    v_cvt_pk_bf16_f32 v10, v160, v161
    v_cvt_pk_bf16_f32 v11, v160, v161
    s_nop 0
    v_mov_b32_dpp v10, v10 row_shr:4 row_mask:0xf bank_mask:0xa
    v_mov_b32_dpp v11, v11 row_shl:4 row_mask:0xf bank_mask:0x5
    s_nop 0
    v_dot2c_f32_bf16_dpp v40, v10, v192 quad_perm:[0,0,0,0] row_mask:0xf bank_mask:0xf
    v_dot2c_f32_bf16_dpp v41, v10, v193 quad_perm:[0,0,0,0] row_mask:0xf bank_mask:0xf
    v_dot2c_f32_bf16_dpp v42, v10, v194 quad_perm:[0,0,0,0] row_mask:0xf bank_mask:0xf
    v_dot2c_f32_bf16_dpp v43, v10, v195 quad_perm:[0,0,0,0] row_mask:0xf bank_mask:0xf
    v_dot2c_f32_bf16_dpp v44, v10, v196 quad_perm:[0,0,0,0] row_mask:0xf bank_mask:0xf
    v_dot2c_f32_bf16_dpp v45, v10, v197 quad_perm:[0,0,0,0] row_mask:0xf bank_mask:0xf
    v_dot2c_f32_bf16_dpp v46, v10, v198 quad_perm:[0,0,0,0] row_mask:0xf bank_mask:0xf
    v_dot2c_f32_bf16_dpp v47, v10, v199 quad_perm:[0,0,0,0] row_mask:0xf bank_mask:0xf
    v_dot2c_f32_bf16_dpp v40, v10, v200 quad_perm:[1,1,1,1] row_mask:0xf bank_mask:0xf
    v_dot2c_f32_bf16_dpp v41, v10, v201 quad_perm:[1,1,1,1] row_mask:0xf bank_mask:0xf
    v_dot2c_f32_bf16_dpp v42, v10, v202 quad_perm:[1,1,1,1] row_mask:0xf bank_mask:0xf
    v_dot2c_f32_bf16_dpp v43, v10, v203 quad_perm:[1,1,1,1] row_mask:0xf bank_mask:0xf
    v_dot2c_f32_bf16_dpp v44, v10, v204 quad_perm:[1,1,1,1] row_mask:0xf bank_mask:0xf
    v_dot2c_f32_bf16_dpp v45, v10, v205 quad_perm:[1,1,1,1] row_mask:0xf bank_mask:0xf
    v_dot2c_f32_bf16_dpp v46, v10, v206 quad_perm:[1,1,1,1] row_mask:0xf bank_mask:0xf
    v_dot2c_f32_bf16_dpp v47, v10, v207 quad_perm:[1,1,1,1] row_mask:0xf bank_mask:0xf
    v_dot2c_f32_bf16_dpp v40, v10, v208 quad_perm:[2,2,2,2] row_mask:0xf bank_mask:0xf
    v_dot2c_f32_bf16_dpp v41, v10, v209 quad_perm:[2,2,2,2] row_mask:0xf bank_mask:0xf
    v_dot2c_f32_bf16_dpp v42, v10, v210 quad_perm:[2,2,2,2] row_mask:0xf bank_mask:0xf
    v_dot2c_f32_bf16_dpp v43, v10, v211 quad_perm:[2,2,2,2] row_mask:0xf bank_mask:0xf
    v_dot2c_f32_bf16_dpp v44, v10, v212 quad_perm:[2,2,2,2] row_mask:0xf bank_mask:0xf
    v_dot2c_f32_bf16_dpp v45, v10, v213 quad_perm:[2,2,2,2] row_mask:0xf bank_mask:0xf
    v_dot2c_f32_bf16_dpp v46, v10, v214 quad_perm:[2,2,2,2] row_mask:0xf bank_mask:0xf
    v_dot2c_f32_bf16_dpp v47, v10, v215 quad_perm:[2,2,2,2] row_mask:0xf bank_mask:0xf
    v_dot2c_f32_bf16_dpp v40, v10, v216 quad_perm:[3,3,3,3] row_mask:0xf bank_mask:0xf
    v_dot2c_f32_bf16_dpp v41, v10, v217 quad_perm:[3,3,3,3] row_mask:0xf bank_mask:0xf
    v_dot2c_f32_bf16_dpp v42, v10, v218 quad_perm:[3,3,3,3] row_mask:0xf bank_mask:0xf
    v_dot2c_f32_bf16_dpp v43, v10, v219 quad_perm:[3,3,3,3] row_mask:0xf bank_mask:0xf
Lhop_15:
    s_cbranch_execz Lhop_16
    v_dot2c_f32_bf16_dpp v44, v10, v220 quad_perm:[3,3,3,3] row_mask:0xf bank_mask:0xf
    v_dot2c_f32_bf16_dpp v45, v10, v221 quad_perm:[3,3,3,3] row_mask:0xf bank_mask:0xf
    v_dot2c_f32_bf16_dpp v46, v10, v222 quad_perm:[3,3,3,3] row_mask:0xf bank_mask:0xf
    v_dot2c_f32_bf16_dpp v47, v10, v223 quad_perm:[3,3,3,3] row_mask:0xf bank_mask:0xf
    v_dot2c_f32_bf16_dpp v40, v11, v224 quad_perm:[0,0,0,0] row_mask:0xf bank_mask:0xf
    v_dot2c_f32_bf16_dpp v41, v11, v225 quad_perm:[0,0,0,0] row_mask:0xf bank_mask:0xf
    v_dot2c_f32_bf16_dpp v42, v11, v226 quad_perm:[0,0,0,0] row_mask:0xf bank_mask:0xf
    v_dot2c_f32_bf16_dpp v43, v11, v227 quad_perm:[0,0,0,0] row_mask:0xf bank_mask:0xf
    v_dot2c_f32_bf16_dpp v44, v11, v228 quad_perm:[0,0,0,0] row_mask:0xf bank_mask:0xf
    v_dot2c_f32_bf16_dpp v45, v11, v229 quad_perm:[0,0,0,0] row_mask:0xf bank_mask:0xf
    v_dot2c_f32_bf16_dpp v46, v11, v230 quad_perm:[0,0,0,0] row_mask:0xf bank_mask:0xf
    v_dot2c_f32_bf16_dpp v47, v11, v231 quad_perm:[0,0,0,0] row_mask:0xf bank_mask:0xf
    v_dot2c_f32_bf16_dpp v40, v11, v232 quad_perm:[1,1,1,1] row_mask:0xf bank_mask:0xf
    v_dot2c_f32_bf16_dpp v41, v11, v233 quad_perm:[1,1,1,1] row_mask:0xf bank_mask:0xf
    v_dot2c_f32_bf16_dpp v42, v11, v234 quad_perm:[1,1,1,1] row_mask:0xf bank_mask:0xf
    v_dot2c_f32_bf16_dpp v43, v11, v235 quad_perm:[1,1,1,1] row_mask:0xf bank_mask:0xf
    v_dot2c_f32_bf16_dpp v44, v11, v236 quad_perm:[1,1,1,1] row_mask:0xf bank_mask:0xf
    v_dot2c_f32_bf16_dpp v45, v11, v237 quad_perm:[1,1,1,1] row_mask:0xf bank_mask:0xf
    v_dot2c_f32_bf16_dpp v46, v11, v238 quad_perm:[1,1,1,1] row_mask:0xf bank_mask:0xf
    v_dot2c_f32_bf16_dpp v47, v11, v239 quad_perm:[1,1,1,1] row_mask:0xf bank_mask:0xf
    v_dot2c_f32_bf16_dpp v40, v11, v240 quad_perm:[2,2,2,2] row_mask:0xf bank_mask:0xf
    v_dot2c_f32_bf16_dpp v41, v11, v241 quad_perm:[2,2,2,2] row_mask:0xf bank_mask:0xf
    v_dot2c_f32_bf16_dpp v42, v11, v242 quad_perm:[2,2,2,2] row_mask:0xf bank_mask:0xf
    v_dot2c_f32_bf16_dpp v43, v11, v243 quad_perm:[2,2,2,2] row_mask:0xf bank_mask:0xf
    v_dot2c_f32_bf16_dpp v44, v11, v244 quad_perm:[2,2,2,2] row_mask:0xf bank_mask:0xf
    v_dot2c_f32_bf16_dpp v45, v11, v245 quad_perm:[2,2,2,2] row_mask:0xf bank_mask:0xf
    v_dot2c_f32_bf16_dpp v46, v11, v246 quad_perm:[2,2,2,2] row_mask:0xf bank_mask:0xf
    v_dot2c_f32_bf16_dpp v47, v11, v247 quad_perm:[2,2,2,2] row_mask:0xf bank_mask:0xf
    ds_read_b32 v62, v167 offset:6160
    ds_read_b64 v[56:57], v164 offset:18432
    ds_read_b64 v[58:59], v165 offset:18432
    ds_read_b64 v[60:61], v166 offset:18432
    v_dot2c_f32_bf16_dpp v40, v11, v248 quad_perm:[3,3,3,3] row_mask:0xf bank_mask:0xf
    v_dot2c_f32_bf16_dpp v41, v11, v249 quad_perm:[3,3,3,3] row_mask:0xf bank_mask:0xf
    v_dot2c_f32_bf16_dpp v42, v11, v250 quad_perm:[3,3,3,3] row_mask:0xf bank_mask:0xf
    v_dot2c_f32_bf16_dpp v43, v11, v251 quad_perm:[3,3,3,3] row_mask:0xf bank_mask:0xf
    v_dot2c_f32_bf16_dpp v44, v11, v252 quad_perm:[3,3,3,3] row_mask:0xf bank_mask:0xf
    v_dot2c_f32_bf16_dpp v45, v11, v253 quad_perm:[3,3,3,3] row_mask:0xf bank_mask:0xf
    v_dot2c_f32_bf16_dpp v46, v11, v254 quad_perm:[3,3,3,3] row_mask:0xf bank_mask:0xf
    v_dot2c_f32_bf16_dpp v47, v11, v255 quad_perm:[3,3,3,3] row_mask:0xf bank_mask:0xf
    v_permlane32_swap_b32 v40, v44
    v_permlane32_swap_b32 v41, v45
    v_permlane32_swap_b32 v42, v46
    v_permlane32_swap_b32 v43, v47
    v_pk_add_f32 v[40:41], v[40:41], v[44:45]
    v_pk_add_f32 v[42:43], v[42:43], v[46:47]
    s_waitcnt lgkmcnt(0)
    v_readfirstlane_b32 s14, v62
    v_pk_add_f32 v[58:59], v[58:59], v[60:61]
    v_permlane16_swap_b32 v40, v42
    v_permlane16_swap_b32 v41, v43
    v_pk_add_f32 v[40:41], v[40:41], v[42:43]
    s_nop 1
    v_add_f32_dpp v40, v40, v40 row_ror:8 row_mask:0xf bank_mask:0xf
    v_add_f32_dpp v41, v41, v41 row_ror:8 row_mask:0xf bank_mask:0xf
    s_cmp_lg_u32 s14, 3
    s_cbranch_scc1 Ll4s_23
Ll4b_24:
    v_pk_add_f32 v[40:41], v[40:41], v[56:57]
    v_pk_add_f32 v[40:41], v[40:41], v[58:59]
    v_and_or_b32 v41, v41, s72, v9
    buffer_store_dwordx2 v[40:41], v14, s[48:51], s75 offen sc1
Lhop_16:
    s_cbranch_execz L_warmdonet
    buffer_store_dwordx2 v[40:41], v191, s[48:51], s27 offen
L_t2done:
    s_cmp_eq_u32 s77, 0
    s_cbranch_scc1 L_fin
    s_barrier
    buffer_load_dwordx4 v[96:99], v8, s[52:55], s6 offen offset:0
    buffer_load_dwordx4 v[100:103], v8, s[52:55], s6 offen offset:1024
    buffer_load_dwordx4 v[104:107], v8, s[52:55], s6 offen offset:2048
    buffer_load_dwordx4 v[108:111], v8, s[52:55], s6 offen offset:3072
    buffer_load_dwordx4 v[112:115], v8, s[52:55], s7 offen offset:0
    buffer_load_dwordx4 v[116:119], v8, s[52:55], s7 offen offset:1024
    buffer_load_dwordx4 v[120:123], v8, s[52:55], s7 offen offset:2048
    buffer_load_dwordx4 v[124:127], v8, s[52:55], s7 offen offset:3072
    s_mov_b32 s15, 0
    buffer_load_dwordx2 v[128:129], v21, s[48:51], s16 offen offset:0 sc1
    buffer_load_dwordx2 v[130:131], v21, s[48:51], s17 offen offset:512 sc1
    buffer_load_dwordx2 v[132:133], v21, s[48:51], s18 offen offset:1024 sc1
    buffer_load_dwordx2 v[134:135], v21, s[48:51], s19 offen offset:1536 sc1
    buffer_load_dwordx2 v[136:137], v21, s[48:51], s20 offen offset:2048 sc1
    buffer_load_dwordx2 v[138:139], v21, s[48:51], s21 offen offset:2560 sc1
    buffer_load_dwordx2 v[140:141], v21, s[48:51], s22 offen offset:3072 sc1
    buffer_load_dwordx2 v[142:143], v21, s[48:51], s23 offen offset:3584 sc1
    s_branch Lpp_25
Lag_28:
    s_add_u32 s15, s15, 1
    s_cmp_gt_u32 s15, 2000000
    s_cbranch_scc1 Lok0_29
    buffer_load_dwordx2 v[128:129], v21, s[48:51], s16 offen offset:0 sc1
    buffer_load_dwordx2 v[130:131], v21, s[48:51], s17 offen offset:512 sc1
    buffer_load_dwordx2 v[132:133], v21, s[48:51], s18 offen offset:1024 sc1
    buffer_load_dwordx2 v[134:135], v21, s[48:51], s19 offen offset:1536 sc1
    buffer_load_dwordx2 v[136:137], v21, s[48:51], s20 offen offset:2048 sc1
    buffer_load_dwordx2 v[138:139], v21, s[48:51], s21 offen offset:2560 sc1
    buffer_load_dwordx2 v[140:141], v21, s[48:51], s22 offen offset:3072 sc1
    buffer_load_dwordx2 v[142:143], v21, s[48:51], s23 offen offset:3584 sc1
    s_waitcnt vmcnt(8)
    v_xor_b32 v145, s47, v145
    v_xor_b32 v147, s47, v147
    v_xor_b32 v149, s47, v149
    v_xor_b32 v151, s47, v151
    v_xor_b32 v153, s47, v153
    v_xor_b32 v155, s47, v155
    v_xor_b32 v157, s47, v157
    v_xor_b32 v159, s47, v159
    v_or3_b32 v10, v145, v147, v149
    v_or3_b32 v10, v10, v151, v153
    v_or3_b32 v10, v10, v155, v157
    v_or_b32 v10, v10, v159
    v_cmp_ne_u32_sdwa vcc, v10, v167 src0_sel:BYTE_0 src1_sel:DWORD
    s_cbranch_vccz Lok1_26
Lpp_25:
    s_and_b32 s14, s15, 3
    s_cmp_eq_u32 s14, 3
    s_cbranch_scc1 Lalt_30
    buffer_load_dwordx2 v[144:145], v21, s[48:51], s16 offen offset:0 sc1
    buffer_load_dwordx2 v[146:147], v21, s[48:51], s17 offen offset:512 sc1
    buffer_load_dwordx2 v[148:149], v21, s[48:51], s18 offen offset:1024 sc1
    buffer_load_dwordx2 v[150:151], v21, s[48:51], s19 offen offset:1536 sc1
    buffer_load_dwordx2 v[152:153], v21, s[48:51], s20 offen offset:2048 sc1
    buffer_load_dwordx2 v[154:155], v21, s[48:51], s21 offen offset:2560 sc1
    buffer_load_dwordx2 v[156:157], v21, s[48:51], s22 offen offset:3072 sc1
    buffer_load_dwordx2 v[158:159], v21, s[48:51], s23 offen offset:3584 sc1
Lback_31:
    s_waitcnt vmcnt(8)
    v_xor_b32 v129, s47, v129
    v_xor_b32 v131, s47, v131
    v_xor_b32 v133, s47, v133
    v_xor_b32 v135, s47, v135
    v_xor_b32 v137, s47, v137
    v_xor_b32 v139, s47, v139
    v_xor_b32 v141, s47, v141
    v_xor_b32 v143, s47, v143
    v_or3_b32 v10, v129, v131, v133
    v_or3_b32 v10, v10, v135, v137
Lhop_17:
    s_cbranch_execz Lhop_18
    v_or3_b32 v10, v10, v139, v141
    v_or_b32 v10, v10, v143
    v_cmp_ne_u32_sdwa vcc, v10, v167 src0_sel:BYTE_0 src1_sel:DWORD
    s_cbranch_vccnz Lag_28
Lok0_29:
    v_pk_add_f32 v[128:129], v[128:129], v[130:131]
    v_pk_add_f32 v[132:133], v[132:133], v[134:135]
    v_pk_add_f32 v[136:137], v[136:137], v[138:139]
    v_pk_add_f32 v[140:141], v[140:141], v[142:143]
    v_pk_add_f32 v[128:129], v[128:129], v[132:133]
    v_pk_add_f32 v[136:137], v[136:137], v[140:141]
    v_pk_add_f32 v[160:161], v[128:129], v[136:137]
Ljoin_27:
    v_cvt_pk_bf16_f32 v160, 0, v160
    v_cvt_pk_bf16_f32 v161, 0, v161
    v_pk_mul_f32 v[160:161], v[160:161], v[24:25]
    v_cvt_pk_bf16_f32 v160, 0, v160
    v_cvt_pk_bf16_f32 v161, 0, v161
    v_pk_add_f32 v[160:161], v[160:161], v[36:37]
    v_cvt_pk_bf16_f32 v10, v160, v161
    v_cvt_pk_bf16_f32 v160, 0, v160
    v_cvt_pk_bf16_f32 v161, 0, v161
    v_pk_mul_f32 v[46:47], v[160:161], v[160:161]
    v_pk_mul_f32 v[40:41], v[168:169], v[160:161] op_sel:[0,0] op_sel_hi:[1,0]
    v_pk_mul_f32 v[42:43], v[170:171], v[160:161] op_sel:[0,0] op_sel_hi:[1,0]
    v_pk_mul_f32 v[44:45], v[172:173], v[46:47] op_sel:[0,0] op_sel_hi:[1,0]
    v_pk_fma_f32 v[40:41], v[174:175], v[160:161], v[40:41] op_sel:[0,1,0] op_sel_hi:[1,1,1]
    v_pk_fma_f32 v[42:43], v[176:177], v[160:161], v[42:43] op_sel:[0,1,0] op_sel_hi:[1,1,1]
    v_pk_fma_f32 v[44:45], v[178:179], v[46:47], v[44:45] op_sel:[0,1,0] op_sel_hi:[1,1,1]
    v_dot2c_f32_bf16_dpp v48, v10, v64 quad_perm:[0,0,0,0] row_mask:0xf bank_mask:0xf
    v_dot2c_f32_bf16_dpp v49, v10, v65 quad_perm:[0,0,0,0] row_mask:0xf bank_mask:0xf
    v_permlane32_swap_b32 v40, v43
    v_permlane32_swap_b32 v41, v44
    v_permlane32_swap_b32 v42, v45
    v_add_f32 v40, v40, v43
    v_add_f32 v41, v41, v44
    v_add_f32 v42, v42, v45
    v_mov_b32 v43, v42
    v_permlane16_swap_b32 v40, v41
    v_dot2c_f32_bf16_dpp v50, v10, v66 quad_perm:[0,0,0,0] row_mask:0xf bank_mask:0xf
    v_permlane16_swap_b32 v42, v43
    v_add_f32 v40, v40, v41
    v_add_f32 v42, v42, v43
    v_dot2c_f32_bf16_dpp v51, v10, v67 quad_perm:[0,0,0,0] row_mask:0xf bank_mask:0xf
    v_add_f32_dpp v40, v40, v40 row_ror:8 row_mask:0xf bank_mask:0x3
    v_add_f32_dpp v40, v42, v42 row_ror:8 row_mask:0xf bank_mask:0xc
    v_dot2c_f32_bf16_dpp v52, v10, v68 quad_perm:[0,0,0,0] row_mask:0xf bank_mask:0xf
    v_dot2c_f32_bf16_dpp v53, v10, v69 quad_perm:[0,0,0,0] row_mask:0xf bank_mask:0xf
    v_add_f32_dpp v40, v40, v40 quad_perm:[1,0,3,2] row_mask:0xf bank_mask:0xf
    v_dot2c_f32_bf16_dpp v54, v10, v70 quad_perm:[0,0,0,0] row_mask:0xf bank_mask:0xf
    v_dot2c_f32_bf16_dpp v55, v10, v71 quad_perm:[0,0,0,0] row_mask:0xf bank_mask:0xf
    v_add_f32_dpp v40, v40, v40 quad_perm:[2,3,0,1] row_mask:0xf bank_mask:0xf
    v_dot2c_f32_bf16_dpp v48, v10, v72 quad_perm:[1,1,1,1] row_mask:0xf bank_mask:0xf
    v_dot2c_f32_bf16_dpp v49, v10, v73 quad_perm:[1,1,1,1] row_mask:0xf bank_mask:0xf
    v_add_f32_dpp v40, v40, v40 row_half_mirror row_mask:0xf bank_mask:0xf
    ds_write_b32 v12, v40 offset:13312
    ds_write_b64 v23, v[160:161] offset:14336
    v_dot2c_f32_bf16_dpp v50, v10, v74 quad_perm:[1,1,1,1] row_mask:0xf bank_mask:0xf
    v_dot2c_f32_bf16_dpp v51, v10, v75 quad_perm:[1,1,1,1] row_mask:0xf bank_mask:0xf
    v_dot2c_f32_bf16_dpp v52, v10, v76 quad_perm:[1,1,1,1] row_mask:0xf bank_mask:0xf
    v_dot2c_f32_bf16_dpp v53, v10, v77 quad_perm:[1,1,1,1] row_mask:0xf bank_mask:0xf
    v_dot2c_f32_bf16_dpp v54, v10, v78 quad_perm:[1,1,1,1] row_mask:0xf bank_mask:0xf
    v_dot2c_f32_bf16_dpp v55, v10, v79 quad_perm:[1,1,1,1] row_mask:0xf bank_mask:0xf
    v_dot2c_f32_bf16_dpp v48, v10, v80 quad_perm:[2,2,2,2] row_mask:0xf bank_mask:0xf
Lhop_18:
    s_cbranch_execz Lhop_19
    v_dot2c_f32_bf16_dpp v49, v10, v81 quad_perm:[2,2,2,2] row_mask:0xf bank_mask:0xf
    v_dot2c_f32_bf16_dpp v50, v10, v82 quad_perm:[2,2,2,2] row_mask:0xf bank_mask:0xf
    v_dot2c_f32_bf16_dpp v51, v10, v83 quad_perm:[2,2,2,2] row_mask:0xf bank_mask:0xf
    v_dot2c_f32_bf16_dpp v52, v10, v84 quad_perm:[2,2,2,2] row_mask:0xf bank_mask:0xf
    v_dot2c_f32_bf16_dpp v53, v10, v85 quad_perm:[2,2,2,2] row_mask:0xf bank_mask:0xf
    v_dot2c_f32_bf16_dpp v54, v10, v86 quad_perm:[2,2,2,2] row_mask:0xf bank_mask:0xf
    v_dot2c_f32_bf16_dpp v55, v10, v87 quad_perm:[2,2,2,2] row_mask:0xf bank_mask:0xf
    v_dot2c_f32_bf16_dpp v48, v10, v88 quad_perm:[3,3,3,3] row_mask:0xf bank_mask:0xf
    v_dot2c_f32_bf16_dpp v49, v10, v89 quad_perm:[3,3,3,3] row_mask:0xf bank_mask:0xf
    ds_read_b128 v[40:43], v13 offset:13312
    v_dot2c_f32_bf16_dpp v50, v10, v90 quad_perm:[3,3,3,3] row_mask:0xf bank_mask:0xf
    v_dot2c_f32_bf16_dpp v51, v10, v91 quad_perm:[3,3,3,3] row_mask:0xf bank_mask:0xf
    v_dot2c_f32_bf16_dpp v52, v10, v92 quad_perm:[3,3,3,3] row_mask:0xf bank_mask:0xf
    v_dot2c_f32_bf16_dpp v53, v10, v93 quad_perm:[3,3,3,3] row_mask:0xf bank_mask:0xf
    v_dot2c_f32_bf16_dpp v54, v10, v94 quad_perm:[3,3,3,3] row_mask:0xf bank_mask:0xf
    v_dot2c_f32_bf16_dpp v55, v10, v95 quad_perm:[3,3,3,3] row_mask:0xf bank_mask:0xf
    v_permlane32_swap_b32 v48, v52
    v_permlane32_swap_b32 v49, v53
    v_permlane32_swap_b32 v50, v54
    v_permlane32_swap_b32 v51, v55
    v_pk_add_f32 v[48:49], v[48:49], v[52:53]
    v_pk_add_f32 v[50:51], v[50:51], v[54:55]
    s_waitcnt lgkmcnt(0)
    v_pk_add_f32 v[40:41], v[40:41], v[42:43]
    v_add_f32 v40, v40, v41
    v_cmp_u_f32 vcc, v40, v40
    s_cbranch_vccnz Lxs_32
Lxd_33:
    v_permlane16_swap_b32 v48, v50
    v_permlane16_swap_b32 v49, v51
    v_pk_add_f32 v[48:49], v[48:49], v[50:51]
    v_mov_b32_dpp v41, v40 row_newbcast:0 row_mask:0xf bank_mask:0xf
    v_mov_b32_dpp v42, v40 row_newbcast:6 row_mask:0xf bank_mask:0xf
    v_add_f32_dpp v48, v48, v48 row_ror:8 row_mask:0xf bank_mask:0x3
    v_add_f32_dpp v48, v49, v49 row_ror:8 row_mask:0xf bank_mask:0xc
    v_mov_b32_dpp v60, v40 row_newbcast:2 row_mask:0xf bank_mask:0xf
    v_mov_b32_dpp v61, v40 row_newbcast:5 row_mask:0xf bank_mask:0xf
    v_add_f32_dpp v48, v48, v48 row_shl:4 row_mask:0xf bank_mask:0x5
    ds_write_b32 v190, v48 offset:13568
    v_mov_b32_dpp v62, v40 row_newbcast:1 row_mask:0xf bank_mask:0xf
    v_mov_b32_dpp v63, v40 row_newbcast:4 row_mask:0xf bank_mask:0xf
    v_fma_f32 v42, -v41, v41, v42
    v_cvt_pk_bf16_f32 v41, 0, v41
    v_max_f32 v42, 0, v42
    v_cvt_pk_bf16_f32 v42, 0, v42
    v_add_f32 v42, 0x3727c5ac, v42
    v_cvt_pk_bf16_f32 v42, 0, v42
    v_sqrt_f32 v42, v42
    v_fma_f32 v60, -v41, v180, v60
    v_cvt_pk_bf16_f32 v42, 0, v42
    v_rcp_f32 v42, v42
    ds_read_b128 v[56:59], v22 offset:13568
    v_fma_f32 v62, v41, v181, v62
    v_fma_f32 v63, -v41, v182, v63
    v_fma_f32 v61, v41, v62, v61
    v_fma_f32 v60, v42, v60, v183
    v_fma_f32 v61, v42, v61, v63
    v_fma_f32 v61, v42, v61, v184
    v_fma_f32 v61, -v60, v60, v61
    v_cvt_pk_bf16_f32 v60, 0, v60
    v_max_f32 v61, 0, v61
    v_cvt_pk_bf16_f32 v61, 0, v61
    v_add_f32 v61, 0x3727c5ac, v61
Lhop_19:
    s_cbranch_execz Lhop_20
    v_cvt_pk_bf16_f32 v61, 0, v61
    v_sqrt_f32 v61, v61
    v_fma_f32 v62, -v60, v185, v186
    v_cvt_pk_bf16_f32 v61, 0, v61
    v_rcp_f32 v61, v61
    s_waitcnt lgkmcnt(0)
    v_pk_add_f32 v[56:57], v[56:57], v[58:59]
    v_add_f32 v56, v56, v57
    v_cmp_u_f32 vcc, v56, v56
    s_cbranch_vccnz Lxs_34
Lxd_35:
    v_fma_f32 v40, -v41, v187, v56
    v_fma_f32 v40, v42, v40, v62
    v_mul_f32 v40, v61, v40
    v_cvt_pk_bf16_f32 v40, 0, v40
    v_add_f32 v40, v40, v38
    v_cvt_pk_bf16_f32 v40, 0, v40
    v_mul_f32 v41, v40, v40
    v_fmac_f32 v189, 0xbdd2d3e8, v41
    v_mul_f32 v41, v189, v40
    v_exp_f32 v41, v41
    ds_read_b32 v31, v34 offset:14336
    v_add_f32 v41, 1.0, v41
    v_rcp_f32 v41, v41
    s_nop 0
    v_mul_f32 v40, v40, v41
    v_cvt_pk_bf16_f32 v40, v40, v40
    s_nop 1
    v_and_b32_dpp v56, v40, v4 quad_perm:[0,0,0,0] row_mask:0xf bank_mask:0xf
    v_and_b32_dpp v57, v40, v5 quad_perm:[0,0,0,0] row_mask:0xf bank_mask:0xf
    v_and_b32_dpp v58, v40, v6 quad_perm:[0,0,0,0] row_mask:0xf bank_mask:0xf
    v_and_b32_dpp v59, v40, v7 quad_perm:[0,0,0,0] row_mask:0xf bank_mask:0xf
    v_and_b32_dpp v60, v40, v4 quad_perm:[1,1,1,1] row_mask:0xf bank_mask:0xf
    v_and_b32_dpp v61, v40, v5 quad_perm:[1,1,1,1] row_mask:0xf bank_mask:0xf
    v_mfma_f32_16x16x32_bf16 v[44:47], v[56:59], v[96:99], 0
    v_and_b32_dpp v62, v40, v6 quad_perm:[1,1,1,1] row_mask:0xf bank_mask:0xf
    v_and_b32_dpp v63, v40, v7 quad_perm:[1,1,1,1] row_mask:0xf bank_mask:0xf
    v_mfma_f32_16x16x32_bf16 v[48:51], v[56:59], v[100:103], 0
    v_and_b32_dpp v56, v40, v4 quad_perm:[2,2,2,2] row_mask:0xf bank_mask:0xf
    v_and_b32_dpp v57, v40, v5 quad_perm:[2,2,2,2] row_mask:0xf bank_mask:0xf
    v_mfma_f32_16x16x32_bf16 v[44:47], v[60:63], v[104:107], v[44:47]
    v_and_b32_dpp v58, v40, v6 quad_perm:[2,2,2,2] row_mask:0xf bank_mask:0xf
    v_and_b32_dpp v59, v40, v7 quad_perm:[2,2,2,2] row_mask:0xf bank_mask:0xf
    v_mfma_f32_16x16x32_bf16 v[48:51], v[60:63], v[108:111], v[48:51]
    v_and_b32_dpp v60, v40, v4 quad_perm:[3,3,3,3] row_mask:0xf bank_mask:0xf
    v_and_b32_dpp v61, v40, v5 quad_perm:[3,3,3,3] row_mask:0xf bank_mask:0xf
    v_mfma_f32_16x16x32_bf16 v[44:47], v[56:59], v[112:115], v[44:47]
    v_and_b32_dpp v62, v40, v6 quad_perm:[3,3,3,3] row_mask:0xf bank_mask:0xf
    v_and_b32_dpp v63, v40, v7 quad_perm:[3,3,3,3] row_mask:0xf bank_mask:0xf
    v_mfma_f32_16x16x32_bf16 v[48:51], v[56:59], v[116:119], v[48:51]
    s_nop 0
    v_mfma_f32_16x16x32_bf16 v[44:47], v[60:63], v[120:123], v[44:47]
    v_mfma_f32_16x16x32_bf16 v[48:51], v[60:63], v[124:127], v[48:51]
    s_nop 7
    v_cndmask_b32 v44, v44, v48, s[12:13]
    v_cndmask_b32 v45, v45, v49, s[12:13]
    v_cndmask_b32 v46, v46, v50, s[12:13]
    v_cndmask_b32 v47, v47, v51, s[12:13]
    s_nop 0
    v_permlane32_swap_b32 v44, v46
    v_permlane32_swap_b32 v45, v47
    v_pk_add_f32 v[44:45], v[44:45], v[46:47]
    v_and_or_b32 v45, v45, s72, v9
    buffer_store_dwordx2 v[44:45], v32, s[48:51], s63 offen sc1
    buffer_store_dwordx2 v[44:45], v32, s[48:51], s28 offen sc1
    s_cmp_ge_u32 s76, 32
    s_cbranch_scc1 L_fin
    s_cmp_lg_u32 s9, 0
Lhop_20:
    s_cbranch_execz Lhop_21
    s_cbranch_scc1 L_fin
    s_waitcnt vmcnt(0)
    s_mov_b32 s15, 0
    buffer_load_dwordx4 v[128:131], v17, s[48:51], s60 offen sc1
    buffer_load_dwordx4 v[132:135], v17, s[48:51], s61 offen sc1
    v_mov_b32 v136, 0
    v_mov_b32 v137, v9
    v_mov_b32 v138, 0
    v_mov_b32 v139, v9
    s_mov_b32 exec_hi, 0xfff
    buffer_load_dwordx4 v[136:139], v17, s[48:51], s8 offen sc1
    s_mov_b32 exec_hi, -1
    s_branch Lpp_36
Lag_39:
    s_add_u32 s15, s15, 1
    s_cmp_gt_u32 s15, 2000000
    s_cbranch_scc1 Lok0_40
    buffer_load_dwordx4 v[128:131], v17, s[48:51], s60 offen sc1
    buffer_load_dwordx4 v[132:135], v17, s[48:51], s61 offen sc1
    v_mov_b32 v136, 0
    v_mov_b32 v137, v9
    v_mov_b32 v138, 0
    v_mov_b32 v139, v9
    s_mov_b32 exec_hi, 0xfff
    buffer_load_dwordx4 v[136:139], v17, s[48:51], s8 offen sc1
    s_mov_b32 exec_hi, -1
    s_waitcnt vmcnt(3)
    v_xor_b32 v145, s47, v145
    v_xor_b32 v147, s47, v147
    v_xor_b32 v149, s47, v149
    v_xor_b32 v151, s47, v151
    v_xor_b32 v153, s47, v153
    v_xor_b32 v155, s47, v155
    v_or3_b32 v10, v145, v147, v149
    v_or3_b32 v10, v10, v151, v153
    v_or_b32 v10, v10, v155
    v_cmp_ne_u32_sdwa vcc, v10, v167 src0_sel:BYTE_0 src1_sel:DWORD
    s_cbranch_vccz Lok1_37
Lpp_36:
    buffer_load_dwordx4 v[144:147], v17, s[48:51], s60 offen sc1
    buffer_load_dwordx4 v[148:151], v17, s[48:51], s61 offen sc1
    v_mov_b32 v152, 0
    v_mov_b32 v153, v9
    v_mov_b32 v154, 0
    v_mov_b32 v155, v9
    s_mov_b32 exec_hi, 0xfff
    buffer_load_dwordx4 v[152:155], v17, s[48:51], s8 offen sc1
    s_mov_b32 exec_hi, -1
    s_waitcnt vmcnt(3)
    v_xor_b32 v129, s47, v129
    v_xor_b32 v131, s47, v131
    v_xor_b32 v133, s47, v133
    v_xor_b32 v135, s47, v135
    v_xor_b32 v137, s47, v137
    v_xor_b32 v139, s47, v139
    v_or3_b32 v10, v129, v131, v133
    v_or3_b32 v10, v10, v135, v137
    v_or_b32 v10, v10, v139
    v_cmp_ne_u32_sdwa vcc, v10, v167 src0_sel:BYTE_0 src1_sel:DWORD
    s_cbranch_vccnz Lag_39
Lok0_40:
    v_pk_add_f32 v[160:161], v[128:129], v[132:133]
    v_pk_add_f32 v[162:163], v[130:131], v[134:135]
    v_pk_add_f32 v[160:161], v[160:161], v[136:137]
    v_pk_add_f32 v[162:163], v[162:163], v[138:139]
Ljoin_38:
    s_nop 1
    v_permlane32_swap_b32 v160, v162
    v_permlane32_swap_b32 v161, v163
    v_pk_add_f32 v[160:161], v[160:161], v[162:163]
    s_nop 1
    v_permlane16_swap_b32 v160, v161
    v_add_f32 v160, v160, v161
    s_nop 1
    v_add_f32_dpp v160, v160, v160 row_ror:8 row_mask:0xf bank_mask:0xf
    s_nop 1
    v_add_f32_dpp v160, v160, v160 row_ror:4 row_mask:0xf bank_mask:0xf
    s_waitcnt lgkmcnt(0)
    v_cvt_pk_bf16_f32 v160, 0, v160
    v_add_f32 v160, v160, v19
    v_cvt_pk_bf16_f32 v160, 0, v160
    v_mul_f32 v160, v160, v30
    v_cvt_pk_bf16_f32 v160, 0, v160
    v_add_f32 v160, v160, v31
    v_cvt_pk_bf16_f32 v160, v160, v160
Lhop_21:
    s_cbranch_execz Lhop_22
    s_mov_b32 exec_lo, 0xf000f
    s_mov_b32 exec_hi, 0xf000f
    buffer_store_short v160, v35, s[56:59], 0 offen
    s_cmp_lg_u32 s2, 0
    s_cbranch_scc1 L_fin
    s_mov_b64 exec, 1
    v_mov_b32 v12, 0
    v_mov_b32 v13, s46
    buffer_store_dword v13, v12, s[48:51], 0 offen offset:4
L_fin:
    s_endpgm
Ll4s_23:
    ds_write_b64 v163, v[40:41] offset:18432
    v_mov_b32 v62, 1
    s_mov_b64 exec, 1
    ds_add_rtn_u32 v62, v167, v62 offset:6160
    s_mov_b64 exec, -1
    ds_read_b64 v[56:57], v164 offset:18432
    ds_read_b64 v[58:59], v165 offset:18432
    ds_read_b64 v[60:61], v166 offset:18432
    s_waitcnt lgkmcnt(0)
    v_readfirstlane_b32 s14, v62
    v_pk_add_f32 v[58:59], v[58:59], v[60:61]
    s_cmp_lg_u32 s14, 3
    s_cbranch_scc1 L_t2done
    s_nop 1
    s_branch Ll4b_24
Lalt_30:
    buffer_load_dwordx2 v[144:145], v21, s[48:51], s62 offen offset:0 sc1
    buffer_load_dwordx2 v[146:147], v21, s[48:51], s62 offen offset:512 sc1
    buffer_load_dwordx2 v[148:149], v21, s[48:51], s62 offen offset:1024 sc1
    buffer_load_dwordx2 v[150:151], v21, s[48:51], s62 offen offset:1536 sc1
    buffer_load_dwordx2 v[152:153], v21, s[48:51], s62 offen offset:2048 sc1
    buffer_load_dwordx2 v[154:155], v21, s[48:51], s62 offen offset:2560 sc1
    buffer_load_dwordx2 v[156:157], v21, s[48:51], s62 offen offset:3072 sc1
    buffer_load_dwordx2 v[158:159], v21, s[48:51], s62 offen offset:3584 sc1
    s_nop 1
    s_branch Lback_31
Lok1_26:
    v_pk_add_f32 v[144:145], v[144:145], v[146:147]
    v_pk_add_f32 v[148:149], v[148:149], v[150:151]
    v_pk_add_f32 v[152:153], v[152:153], v[154:155]
    v_pk_add_f32 v[156:157], v[156:157], v[158:159]
    v_pk_add_f32 v[144:145], v[144:145], v[148:149]
    v_pk_add_f32 v[152:153], v[152:153], v[156:157]
    v_pk_add_f32 v[160:161], v[144:145], v[152:153]
    s_nop 1
    s_branch Ljoin_27
Lxs_32:
    ds_read_b128 v[40:43], v13 offset:13312
    s_add_u32 s70, s70, 1
    s_waitcnt lgkmcnt(0)
    v_pk_add_f32 v[40:41], v[40:41], v[42:43]
    v_add_f32 v40, v40, v41
    v_cmp_u_f32 vcc, v40, v40
    s_and_b32 s14, s70, 63
    s_cbranch_vccz Lxd_33
    s_cbranch_scc1 Lxs_32
    ds_read_b128 v[40:43], v13 offset:13312
    s_waitcnt lgkmcnt(0)
    v_max_u32 v39, v40, v41
    v_max_u32 v39, v39, v42
    v_max_u32 v39, v39, v43
    v_pk_add_f32 v[40:41], v[40:41], v[42:43]
    v_add_f32 v40, v40, v41
    s_cmp_gt_u32 s70, 16000000
    s_cbranch_scc1 Lxd_33
    v_cmp_eq_u32 vcc, -1, v39
    s_cbranch_vccnz Lxs_32
    s_nop 1
    s_branch Lxd_33
Lxs_34:
    ds_read_b128 v[56:59], v22 offset:13568
    s_add_u32 s70, s70, 1
    s_waitcnt lgkmcnt(0)
    v_pk_add_f32 v[56:57], v[56:57], v[58:59]
    v_add_f32 v56, v56, v57
    v_cmp_u_f32 vcc, v56, v56
    s_and_b32 s14, s70, 63
    s_cbranch_vccz Lxd_35
Lhop_22:
    s_cbranch_execz L_warmdonet
    s_cbranch_scc1 Lxs_34
    ds_read_b128 v[56:59], v22 offset:13568
    s_waitcnt lgkmcnt(0)
    v_max_u32 v39, v56, v57
    v_max_u32 v39, v39, v58
    v_max_u32 v39, v39, v59
    v_pk_add_f32 v[56:57], v[56:57], v[58:59]
    v_add_f32 v56, v56, v57
    s_cmp_gt_u32 s70, 16000000
    s_cbranch_scc1 Lxd_35
    v_cmp_eq_u32 vcc, -1, v39
    s_cbranch_vccnz Lxs_34
    s_nop 1
    s_branch Lxd_35
Lok1_37:
    v_pk_add_f32 v[160:161], v[144:145], v[148:149]
    v_pk_add_f32 v[162:163], v[146:147], v[150:151]
    v_pk_add_f32 v[160:161], v[160:161], v[152:153]
    v_pk_add_f32 v[162:163], v[162:163], v[154:155]
    s_nop 1
    s_branch Ljoin_38
L_A0:
.p2align 12
L_K:
Lhop_23:
    s_cbranch_execz Lhop_24
    s_mov_b32 s48, s44
    s_and_b32 s49, s45, 0xffff
    s_mov_b32 s50, 1048576
    s_mov_b32 s51, 0x20000
    s_waitcnt lgkmcnt(0)
    s_add_u32 s46, s46, 1
    s_and_b32 s47, s46, 0xff
    s_and_b32 s71, s46, 0xffff
    s_mov_b32 s72, 0xffffff00
    v_and_b32 v8, 15, v0
    v_lshlrev_b32 v8, 5, v8
    s_lshl_b32 s10, s6, 9
    s_add_u32 s10, s10, 65536
    s_mov_b32 s15, 0
    buffer_load_dwordx4 v[12:15], v8, s[48:51], s10 offen nt
    buffer_load_dwordx4 v[16:19], v8, s[48:51], s10 offen offset:16 nt
    s_branch Lpoll_41
Lretry_42:
    s_add_u32 s15, s15, 1
    s_cmp_gt_u32 s15, 2000000
    s_cbranch_scc1 Ldone_43
    s_sleep 16
    s_and_b32 s14, s15, 3
    s_cmp_eq_u32 s14, 3
    s_cselect_b32 s14, 524288, 0
    s_andn2_b32 s10, s10, 524288
    s_or_b32 s10, s10, s14
    buffer_load_dwordx4 v[12:15], v8, s[48:51], s10 offen sc1
    buffer_load_dwordx4 v[16:19], v8, s[48:51], s10 offen offset:16 sc1
Lpoll_41:
    s_waitcnt vmcnt(0)
    v_xor_b32 v12, s71, v12
    v_xor_b32 v13, s71, v13
    v_xor_b32 v14, s71, v14
    v_xor_b32 v15, s71, v15
    v_xor_b32 v16, s71, v16
    v_xor_b32 v17, s71, v17
    v_xor_b32 v18, s71, v18
    v_xor_b32 v19, s71, v19
    v_or3_b32 v10, v12, v13, v14
    v_or3_b32 v11, v16, v17, v18
    v_or_b32 v10, v10, v15
    v_or_b32 v11, v11, v19
    v_or_b32 v10, v10, v11
    v_and_b32 v10, 0xffff, v10
    v_cmp_ne_u32 vcc, 0, v10
    s_cbranch_vccnz Lretry_42
Ldone_43:
    s_mov_b32 s74, 0x07060302
    v_perm_b32 v4, v13, v12, s74
    v_perm_b32 v5, v15, v14, s74
    v_perm_b32 v6, v17, v16, s74
    v_perm_b32 v7, v19, v18, s74
    v_dot2_f32_bf16 v80, v80, v4, 0
    v_dot2_f32_bf16 v84, v84, v4, 0
    v_dot2_f32_bf16 v88, v88, v4, 0
    v_dot2_f32_bf16 v92, v92, v4, 0
    v_dot2_f32_bf16 v96, v96, v4, 0
    v_dot2_f32_bf16 v100, v100, v4, 0
    v_dot2_f32_bf16 v104, v104, v4, 0
    v_dot2_f32_bf16 v108, v108, v4, 0
    v_dot2_f32_bf16 v80, v81, v5, v80
    v_dot2_f32_bf16 v84, v85, v5, v84
    v_dot2_f32_bf16 v88, v89, v5, v88
    v_dot2_f32_bf16 v92, v93, v5, v92
    v_dot2_f32_bf16 v96, v97, v5, v96
    v_dot2_f32_bf16 v100, v101, v5, v100
    v_dot2_f32_bf16 v104, v105, v5, v104
    v_dot2_f32_bf16 v108, v109, v5, v108
    v_dot2_f32_bf16 v80, v82, v6, v80
    v_dot2_f32_bf16 v84, v86, v6, v84
    v_dot2_f32_bf16 v88, v90, v6, v88
Lhop_24:
    s_cbranch_execz Lhop_25
    v_dot2_f32_bf16 v92, v94, v6, v92
    v_dot2_f32_bf16 v96, v98, v6, v96
    v_dot2_f32_bf16 v100, v102, v6, v100
    v_dot2_f32_bf16 v104, v106, v6, v104
    v_dot2_f32_bf16 v108, v110, v6, v108
    v_dot2_f32_bf16 v80, v83, v7, v80
    v_dot2_f32_bf16 v84, v87, v7, v84
    v_dot2_f32_bf16 v88, v91, v7, v88
    v_dot2_f32_bf16 v92, v95, v7, v92
    v_dot2_f32_bf16 v96, v99, v7, v96
    v_dot2_f32_bf16 v100, v103, v7, v100
    v_dot2_f32_bf16 v104, v107, v7, v104
    v_dot2_f32_bf16 v108, v111, v7, v108
    v_add_f32_dpp v80, v80, v80 row_ror:8 row_mask:0xf bank_mask:0x3
    v_add_f32_dpp v88, v88, v88 row_ror:8 row_mask:0xf bank_mask:0x3
    v_add_f32_dpp v96, v96, v96 row_ror:8 row_mask:0xf bank_mask:0x3
    v_add_f32_dpp v104, v104, v104 row_ror:8 row_mask:0xf bank_mask:0x3
    v_add_f32_dpp v80, v84, v84 row_ror:8 row_mask:0xf bank_mask:0xc
    v_add_f32_dpp v88, v92, v92 row_ror:8 row_mask:0xf bank_mask:0xc
    v_add_f32_dpp v96, v100, v100 row_ror:8 row_mask:0xf bank_mask:0xc
    v_add_f32_dpp v104, v108, v108 row_ror:8 row_mask:0xf bank_mask:0xc
    v_add_f32_dpp v80, v80, v80 row_shl:4 row_mask:0xf bank_mask:0x5
    v_add_f32_dpp v96, v96, v96 row_shl:4 row_mask:0xf bank_mask:0x5
    v_add_f32_dpp v80, v88, v88 row_shr:4 row_mask:0xf bank_mask:0xa
    v_add_f32_dpp v96, v104, v104 row_shr:4 row_mask:0xf bank_mask:0xa
    v_dot2_f32_bf16 v112, v112, v4, 0
    v_dot2_f32_bf16 v116, v116, v4, 0
    v_dot2_f32_bf16 v120, v120, v4, 0
    v_dot2_f32_bf16 v124, v124, v4, 0
    v_dot2_f32_bf16 v128, v128, v4, 0
    v_dot2_f32_bf16 v132, v132, v4, 0
    v_dot2_f32_bf16 v136, v136, v4, 0
    v_dot2_f32_bf16 v140, v140, v4, 0
    v_dot2_f32_bf16 v112, v113, v5, v112
    v_dot2_f32_bf16 v116, v117, v5, v116
    v_dot2_f32_bf16 v120, v121, v5, v120
    v_dot2_f32_bf16 v124, v125, v5, v124
    v_dot2_f32_bf16 v128, v129, v5, v128
    v_dot2_f32_bf16 v132, v133, v5, v132
    v_dot2_f32_bf16 v136, v137, v5, v136
    v_dot2_f32_bf16 v140, v141, v5, v140
    v_dot2_f32_bf16 v112, v114, v6, v112
    v_dot2_f32_bf16 v116, v118, v6, v116
    v_dot2_f32_bf16 v120, v122, v6, v120
    v_dot2_f32_bf16 v124, v126, v6, v124
    v_dot2_f32_bf16 v128, v130, v6, v128
    v_dot2_f32_bf16 v132, v134, v6, v132
    v_dot2_f32_bf16 v136, v138, v6, v136
    v_dot2_f32_bf16 v140, v142, v6, v140
    v_dot2_f32_bf16 v112, v115, v7, v112
    v_dot2_f32_bf16 v116, v119, v7, v116
    v_dot2_f32_bf16 v120, v123, v7, v120
    v_dot2_f32_bf16 v124, v127, v7, v124
    v_dot2_f32_bf16 v128, v131, v7, v128
    v_dot2_f32_bf16 v132, v135, v7, v132
Lhop_25:
    s_cbranch_execz Lhop_26
    v_dot2_f32_bf16 v136, v139, v7, v136
    v_dot2_f32_bf16 v140, v143, v7, v140
    v_add_f32_dpp v112, v112, v112 row_ror:8 row_mask:0xf bank_mask:0x3
    v_add_f32_dpp v120, v120, v120 row_ror:8 row_mask:0xf bank_mask:0x3
    v_add_f32_dpp v128, v128, v128 row_ror:8 row_mask:0xf bank_mask:0x3
    v_add_f32_dpp v136, v136, v136 row_ror:8 row_mask:0xf bank_mask:0x3
    v_add_f32_dpp v112, v116, v116 row_ror:8 row_mask:0xf bank_mask:0xc
    v_add_f32_dpp v120, v124, v124 row_ror:8 row_mask:0xf bank_mask:0xc
    v_add_f32_dpp v128, v132, v132 row_ror:8 row_mask:0xf bank_mask:0xc
    v_add_f32_dpp v136, v140, v140 row_ror:8 row_mask:0xf bank_mask:0xc
    v_add_f32_dpp v112, v112, v112 row_shl:4 row_mask:0xf bank_mask:0x5
    v_add_f32_dpp v128, v128, v128 row_shl:4 row_mask:0xf bank_mask:0x5
    v_add_f32_dpp v112, v120, v120 row_shr:4 row_mask:0xf bank_mask:0xa
    v_add_f32_dpp v128, v136, v136 row_shr:4 row_mask:0xf bank_mask:0xa
    v_dot2_f32_bf16 v144, v144, v4, 0
    v_dot2_f32_bf16 v148, v148, v4, 0
    v_dot2_f32_bf16 v152, v152, v4, 0
    v_dot2_f32_bf16 v156, v156, v4, 0
    v_dot2_f32_bf16 v160, v160, v4, 0
    v_dot2_f32_bf16 v164, v164, v4, 0
    v_dot2_f32_bf16 v168, v168, v4, 0
    v_dot2_f32_bf16 v172, v172, v4, 0
    v_dot2_f32_bf16 v144, v145, v5, v144
    v_dot2_f32_bf16 v148, v149, v5, v148
    v_dot2_f32_bf16 v152, v153, v5, v152
    v_dot2_f32_bf16 v156, v157, v5, v156
    v_dot2_f32_bf16 v160, v161, v5, v160
    v_dot2_f32_bf16 v164, v165, v5, v164
    v_dot2_f32_bf16 v168, v169, v5, v168
    v_dot2_f32_bf16 v172, v173, v5, v172
    v_dot2_f32_bf16 v144, v146, v6, v144
    v_dot2_f32_bf16 v148, v150, v6, v148
    v_dot2_f32_bf16 v152, v154, v6, v152
    v_dot2_f32_bf16 v156, v158, v6, v156
    v_dot2_f32_bf16 v160, v162, v6, v160
    v_dot2_f32_bf16 v164, v166, v6, v164
    v_dot2_f32_bf16 v168, v170, v6, v168
    v_dot2_f32_bf16 v172, v174, v6, v172
    v_dot2_f32_bf16 v144, v147, v7, v144
    v_dot2_f32_bf16 v148, v151, v7, v148
    v_dot2_f32_bf16 v152, v155, v7, v152
    v_dot2_f32_bf16 v156, v159, v7, v156
    v_dot2_f32_bf16 v160, v163, v7, v160
    v_dot2_f32_bf16 v164, v167, v7, v164
    v_dot2_f32_bf16 v168, v171, v7, v168
    v_dot2_f32_bf16 v172, v175, v7, v172
    v_add_f32_dpp v144, v144, v144 row_ror:8 row_mask:0xf bank_mask:0x3
    v_add_f32_dpp v152, v152, v152 row_ror:8 row_mask:0xf bank_mask:0x3
    v_add_f32_dpp v160, v160, v160 row_ror:8 row_mask:0xf bank_mask:0x3
    v_add_f32_dpp v168, v168, v168 row_ror:8 row_mask:0xf bank_mask:0x3
    v_add_f32_dpp v144, v148, v148 row_ror:8 row_mask:0xf bank_mask:0xc
    v_add_f32_dpp v152, v156, v156 row_ror:8 row_mask:0xf bank_mask:0xc
    v_add_f32_dpp v160, v164, v164 row_ror:8 row_mask:0xf bank_mask:0xc
    v_add_f32_dpp v168, v172, v172 row_ror:8 row_mask:0xf bank_mask:0xc
    v_add_f32_dpp v144, v144, v144 row_shl:4 row_mask:0xf bank_mask:0x5
Lhop_26:
    s_cbranch_execz L_warmdonea
    v_add_f32_dpp v160, v160, v160 row_shl:4 row_mask:0xf bank_mask:0x5
    v_add_f32_dpp v144, v152, v152 row_shr:4 row_mask:0xf bank_mask:0xa
    v_add_f32_dpp v160, v168, v168 row_shr:4 row_mask:0xf bank_mask:0xa
    v_dot2_f32_bf16 v176, v176, v4, 0
    v_dot2_f32_bf16 v180, v180, v4, 0
    v_dot2_f32_bf16 v184, v184, v4, 0
    v_dot2_f32_bf16 v188, v188, v4, 0
    v_dot2_f32_bf16 v192, v192, v4, 0
    v_dot2_f32_bf16 v196, v196, v4, 0
    v_dot2_f32_bf16 v200, v200, v4, 0
    v_dot2_f32_bf16 v204, v204, v4, 0
    v_dot2_f32_bf16 v176, v177, v5, v176
    v_dot2_f32_bf16 v180, v181, v5, v180
    v_dot2_f32_bf16 v184, v185, v5, v184
    v_dot2_f32_bf16 v188, v189, v5, v188
    v_dot2_f32_bf16 v192, v193, v5, v192
    v_dot2_f32_bf16 v196, v197, v5, v196
    v_dot2_f32_bf16 v200, v201, v5, v200
    v_dot2_f32_bf16 v204, v205, v5, v204
    v_dot2_f32_bf16 v176, v178, v6, v176
    v_dot2_f32_bf16 v180, v182, v6, v180
    v_dot2_f32_bf16 v184, v186, v6, v184
    v_dot2_f32_bf16 v188, v190, v6, v188
    v_dot2_f32_bf16 v192, v194, v6, v192
    v_dot2_f32_bf16 v196, v198, v6, v196
    v_dot2_f32_bf16 v200, v202, v6, v200
    v_dot2_f32_bf16 v204, v206, v6, v204
    v_dot2_f32_bf16 v176, v179, v7, v176
    v_dot2_f32_bf16 v180, v183, v7, v180
    v_dot2_f32_bf16 v184, v187, v7, v184
    v_dot2_f32_bf16 v188, v191, v7, v188
    v_dot2_f32_bf16 v192, v195, v7, v192
    v_dot2_f32_bf16 v196, v199, v7, v196
    v_dot2_f32_bf16 v200, v203, v7, v200
    v_dot2_f32_bf16 v204, v207, v7, v204
    v_add_f32_dpp v176, v176, v176 row_ror:8 row_mask:0xf bank_mask:0x3
    v_add_f32_dpp v184, v184, v184 row_ror:8 row_mask:0xf bank_mask:0x3
    v_add_f32_dpp v192, v192, v192 row_ror:8 row_mask:0xf bank_mask:0x3
    v_add_f32_dpp v200, v200, v200 row_ror:8 row_mask:0xf bank_mask:0x3
    v_add_f32_dpp v176, v180, v180 row_ror:8 row_mask:0xf bank_mask:0xc
    v_add_f32_dpp v184, v188, v188 row_ror:8 row_mask:0xf bank_mask:0xc
    v_add_f32_dpp v192, v196, v196 row_ror:8 row_mask:0xf bank_mask:0xc
    v_add_f32_dpp v200, v204, v204 row_ror:8 row_mask:0xf bank_mask:0xc
    v_add_f32_dpp v176, v176, v176 row_shl:4 row_mask:0xf bank_mask:0x5
    v_add_f32_dpp v192, v192, v192 row_shl:4 row_mask:0xf bank_mask:0x5
    v_add_f32_dpp v176, v184, v184 row_shr:4 row_mask:0xf bank_mask:0xa
    v_add_f32_dpp v192, v200, v200 row_shr:4 row_mask:0xf bank_mask:0xa
    v_dot2_f32_bf16 v208, v208, v4, 0
    v_dot2_f32_bf16 v212, v212, v4, 0
    v_dot2_f32_bf16 v216, v216, v4, 0
    v_dot2_f32_bf16 v220, v220, v4, 0
    v_dot2_f32_bf16 v224, v224, v4, 0
    v_dot2_f32_bf16 v228, v228, v4, 0
    v_dot2_f32_bf16 v232, v232, v4, 0
    v_dot2_f32_bf16 v236, v236, v4, 0
Lhop_27:
    s_cbranch_execz Lhop_28
    v_dot2_f32_bf16 v208, v209, v5, v208
    v_dot2_f32_bf16 v212, v213, v5, v212
    v_dot2_f32_bf16 v216, v217, v5, v216
    v_dot2_f32_bf16 v220, v221, v5, v220
    v_dot2_f32_bf16 v224, v225, v5, v224
    v_dot2_f32_bf16 v228, v229, v5, v228
    v_dot2_f32_bf16 v232, v233, v5, v232
    v_dot2_f32_bf16 v236, v237, v5, v236
    v_dot2_f32_bf16 v208, v210, v6, v208
    v_dot2_f32_bf16 v212, v214, v6, v212
    v_dot2_f32_bf16 v216, v218, v6, v216
    v_dot2_f32_bf16 v220, v222, v6, v220
    v_dot2_f32_bf16 v224, v226, v6, v224
    v_dot2_f32_bf16 v228, v230, v6, v228
    v_dot2_f32_bf16 v232, v234, v6, v232
    v_dot2_f32_bf16 v236, v238, v6, v236
    v_dot2_f32_bf16 v208, v211, v7, v208
    v_dot2_f32_bf16 v212, v215, v7, v212
    v_dot2_f32_bf16 v216, v219, v7, v216
    v_dot2_f32_bf16 v220, v223, v7, v220
    v_dot2_f32_bf16 v224, v227, v7, v224
    v_dot2_f32_bf16 v228, v231, v7, v228
    v_dot2_f32_bf16 v232, v235, v7, v232
    v_dot2_f32_bf16 v236, v239, v7, v236
    v_add_f32_dpp v208, v208, v208 row_ror:8 row_mask:0xf bank_mask:0x3
    v_add_f32_dpp v216, v216, v216 row_ror:8 row_mask:0xf bank_mask:0x3
    v_add_f32_dpp v224, v224, v224 row_ror:8 row_mask:0xf bank_mask:0x3
    v_add_f32_dpp v232, v232, v232 row_ror:8 row_mask:0xf bank_mask:0x3
    v_add_f32_dpp v208, v212, v212 row_ror:8 row_mask:0xf bank_mask:0xc
    v_add_f32_dpp v216, v220, v220 row_ror:8 row_mask:0xf bank_mask:0xc
    v_add_f32_dpp v224, v228, v228 row_ror:8 row_mask:0xf bank_mask:0xc
    v_add_f32_dpp v232, v236, v236 row_ror:8 row_mask:0xf bank_mask:0xc
    v_add_f32_dpp v208, v208, v208 row_shl:4 row_mask:0xf bank_mask:0x5
    v_add_f32_dpp v224, v224, v224 row_shl:4 row_mask:0xf bank_mask:0x5
    v_add_f32_dpp v208, v216, v216 row_shr:4 row_mask:0xf bank_mask:0xa
    v_add_f32_dpp v224, v232, v232 row_shr:4 row_mask:0xf bank_mask:0xa
    v_dot2_f32_bf16 v240, v240, v4, 0
    v_dot2_f32_bf16 v244, v244, v4, 0
    v_dot2_f32_bf16 v248, v248, v4, 0
    v_dot2_f32_bf16 v240, v241, v5, v240
    v_dot2_f32_bf16 v244, v245, v5, v244
    v_dot2_f32_bf16 v248, v249, v5, v248
    v_dot2_f32_bf16 v240, v242, v6, v240
    v_dot2_f32_bf16 v244, v246, v6, v244
    v_dot2_f32_bf16 v248, v250, v6, v248
    v_dot2_f32_bf16 v240, v243, v7, v240
    v_dot2_f32_bf16 v244, v247, v7, v244
    v_dot2_f32_bf16 v248, v251, v7, v248
    s_nop 0
    v_add_f32_dpp v240, v240, v240 row_ror:8 row_mask:0xf bank_mask:0x3
    s_nop 0
    v_add_f32_dpp v248, v248, v248 row_ror:8 row_mask:0xf bank_mask:0x3
    v_add_f32_dpp v240, v244, v244 row_ror:8 row_mask:0xf bank_mask:0xc
    s_nop 1
    v_add_f32_dpp v240, v240, v240 row_shl:4 row_mask:0xf bank_mask:0x5
    v_add_f32_dpp v240, v248, v248 row_shr:4 row_mask:0xf bank_mask:0xa
    v_add_f32_dpp v80, v80, v80 quad_perm:[1,0,3,2] row_mask:0xf bank_mask:0xf
Lhop_28:
    s_cbranch_execz Lhop_29
    v_add_f32_dpp v96, v96, v96 quad_perm:[1,0,3,2] row_mask:0xf bank_mask:0xf
    v_add_f32_dpp v112, v112, v112 quad_perm:[1,0,3,2] row_mask:0xf bank_mask:0xf
    v_add_f32_dpp v128, v128, v128 quad_perm:[1,0,3,2] row_mask:0xf bank_mask:0xf
    v_add_f32_dpp v144, v144, v144 quad_perm:[1,0,3,2] row_mask:0xf bank_mask:0xf
    v_add_f32_dpp v160, v160, v160 quad_perm:[1,0,3,2] row_mask:0xf bank_mask:0xf
    v_add_f32_dpp v176, v176, v176 quad_perm:[1,0,3,2] row_mask:0xf bank_mask:0xf
    v_add_f32_dpp v192, v192, v192 quad_perm:[1,0,3,2] row_mask:0xf bank_mask:0xf
    v_add_f32_dpp v208, v208, v208 quad_perm:[1,0,3,2] row_mask:0xf bank_mask:0xf
    v_add_f32_dpp v224, v224, v224 quad_perm:[1,0,3,2] row_mask:0xf bank_mask:0xf
    v_add_f32_dpp v240, v240, v240 quad_perm:[1,0,3,2] row_mask:0xf bank_mask:0xf
    v_add_f32_dpp v80, v80, v80 quad_perm:[2,3,0,1] row_mask:0xf bank_mask:0xf
    v_add_f32_dpp v96, v96, v96 quad_perm:[2,3,0,1] row_mask:0xf bank_mask:0xf
    v_add_f32_dpp v112, v112, v112 quad_perm:[2,3,0,1] row_mask:0xf bank_mask:0xf
    v_add_f32_dpp v128, v128, v128 quad_perm:[2,3,0,1] row_mask:0xf bank_mask:0xf
    v_add_f32_dpp v144, v144, v144 quad_perm:[2,3,0,1] row_mask:0xf bank_mask:0xf
    v_add_f32_dpp v160, v160, v160 quad_perm:[2,3,0,1] row_mask:0xf bank_mask:0xf
    v_add_f32_dpp v176, v176, v176 quad_perm:[2,3,0,1] row_mask:0xf bank_mask:0xf
    v_add_f32_dpp v192, v192, v192 quad_perm:[2,3,0,1] row_mask:0xf bank_mask:0xf
    v_add_f32_dpp v208, v208, v208 quad_perm:[2,3,0,1] row_mask:0xf bank_mask:0xf
    v_add_f32_dpp v224, v224, v224 quad_perm:[2,3,0,1] row_mask:0xf bank_mask:0xf
    v_add_f32_dpp v240, v240, v240 quad_perm:[2,3,0,1] row_mask:0xf bank_mask:0xf
    s_mov_b32 s10, 0x22222222
    s_mov_b32 s11, 0x22222222
    v_cndmask_b32 v24, v80, v96, s[10:11]
    v_cndmask_b32 v25, v144, v160, s[10:11]
    v_cndmask_b32 v26, v208, v224, s[10:11]
    s_mov_b32 s10, 0x44444444
    s_mov_b32 s11, 0x44444444
    v_cndmask_b32 v24, v24, v112, s[10:11]
    v_cndmask_b32 v25, v25, v176, s[10:11]
    v_cndmask_b32 v26, v26, v240, s[10:11]
    s_mov_b32 s10, 0x88888888
    s_mov_b32 s11, 0x88888888
    v_cndmask_b32 v24, v24, v128, s[10:11]
    v_cndmask_b32 v25, v25, v192, s[10:11]
    v_cvt_pk_bf16_f32 v24, 0, v24
    v_cvt_pk_bf16_f32 v25, 0, v25
    v_cvt_pk_bf16_f32 v26, 0, v26
    v_mul_f32 v24, 0x3db504f3, v24
    v_mul_f32 v25, 0x3db504f3, v25
    v_mul_f32 v26, 0x3db504f3, v26
    v_cvt_pk_bf16_f32 v24, 0, v24
    v_cvt_pk_bf16_f32 v25, 0, v25
    v_cvt_pk_bf16_f32 v26, 0, v26
    s_cmp_eq_u32 s78, 0
    s_cselect_b32 s10, 0x00400040, 0
    s_or_b32 s10, s10, 0xc888c888
    s_mov_b32 s11, s10
    v_mov_b32 v12, 0xff800000
    v_cndmask_b32 v26, v26, v12, s[10:11]
    v_max3_f32 v40, v24, v25, v26
    s_nop 1
    v_max_f32_dpp v40, v40, v40 quad_perm:[1,0,3,2] row_mask:0xf bank_mask:0xf
    s_nop 1
    v_max_f32_dpp v40, v40, v40 quad_perm:[2,3,0,1] row_mask:0xf bank_mask:0xf
    s_nop 1
    v_max_f32_dpp v40, v40, v40 row_half_mirror row_mask:0xf bank_mask:0xf
    s_nop 1
    v_max_f32_dpp v40, v40, v40 row_mirror row_mask:0xf bank_mask:0xf
Lhop_29:
    s_cbranch_execz Lhop_30
    v_mov_b32 v12, v40
    s_nop 1
    v_permlane16_swap_b32 v40, v12
    v_max_f32 v40, v40, v12
    v_mov_b32 v12, v40
    s_nop 1
    v_permlane32_swap_b32 v40, v12
    v_max_f32 v40, v40, v12
    v_sub_f32 v24, v24, v40
    v_sub_f32 v25, v25, v40
    v_sub_f32 v26, v26, v40
    v_mul_f32 v24, 0x3fb8aa3b, v24
    v_mul_f32 v25, 0x3fb8aa3b, v25
    v_mul_f32 v26, 0x3fb8aa3b, v26
    v_exp_f32 v24, v24
    v_exp_f32 v25, v25
    v_exp_f32 v26, v26
    v_lshrrev_b32 v13, 3, v0
    v_mul_u32_u24 v13, 96, v13
    v_and_b32 v14, 3, v0
    v_lshl_add_u32 v13, v14, 3, v13
    v_and_b32 v14, 4, v0
    s_mul_i32 s10, s9, 768
    v_add3_u32 v13, v13, v14, s10
    v_add_f32 v41, v24, v25
    v_add_f32 v41, v41, v26
    v_cvt_pk_bf16_f32 v24, v24, v24
    v_cvt_pk_bf16_f32 v25, v25, v25
    v_cvt_pk_bf16_f32 v26, v26, v26
    ds_write_b32 v13, v24 offset:0
    ds_write_b32 v13, v25 offset:32
    ds_write_b32 v13, v26 offset:64
    s_lshl_b32 s10, s9, 2
    v_mov_b32 v12, s10
    s_mov_b64 exec, 1
    ds_write_b32 v12, v40 offset:3072
    v_mov_b32 v14, 0
    v_mov_b32 v15, 1
    s_mov_b64 exec, -1
    v_add_f32_dpp v41, v41, v41 quad_perm:[1,0,3,2] row_mask:0xf bank_mask:0xf
    s_nop 1
    v_add_f32_dpp v41, v41, v41 quad_perm:[2,3,0,1] row_mask:0xf bank_mask:0xf
    s_nop 1
    v_add_f32_dpp v41, v41, v41 row_half_mirror row_mask:0xf bank_mask:0xf
    s_nop 1
    v_add_f32_dpp v41, v41, v41 row_mirror row_mask:0xf bank_mask:0xf
    v_mov_b32 v12, v41
    s_nop 1
    v_permlane16_swap_b32 v41, v12
    v_add_f32 v41, v41, v12
    v_mov_b32 v12, v41
    s_nop 1
    v_permlane32_swap_b32 v41, v12
    v_add_f32 v41, v41, v12
    v_mov_b32 v43, s47
    s_getreg_b32 s10, hwreg(HW_REG_XCC_ID)
    s_lshl_b32 s10, s10, 8
    v_and_or_b32 v40, v40, s72, v43
    v_and_or_b32 v41, v41, s72, v43
    v_or_b32 v42, s10, v43
    v_mov_b32 v12, 0
    s_lshl_b32 s10, s6, 9
    s_lshl_b32 s11, s7, 6
    s_add_u32 s10, s10, s11
    s_lshl_b32 s11, s9, 4
    s_add_u32 s10, s10, s11
    s_add_u32 s10, s10, 81920
    s_add_u32 s11, s10, 524288
    s_mov_b64 exec, 1
    s_lshl_b32 s11, s9, 4
    v_mov_b32 v13, s11
    ds_write_b128 v13, v[40:43] offset:3136
    ds_add_u32 v14, v15 offset:3092
    buffer_store_dwordx4 v[40:43], v12, s[48:51], s10 offen
    s_waitcnt lgkmcnt(0)
    s_mov_b64 exec, -1
    s_mov_b32 s56, s32
    s_and_b32 s57, s33, 0xffff
    s_mov_b32 s58, 1409024
    s_mov_b32 s59, 0x20000
    v_lshrrev_b32 v2, 1, v0
    v_lshlrev_b32 v2, 10, v2
    v_and_b32 v3, 1, v0
Lhop_30:
    s_cbranch_execz L_warmdonea
    v_lshl_add_u32 v2, v3, 7, v2
    s_mul_i32 s10, s4, 6
    s_add_u32 s10, s10, s7
    s_lshl_b32 s10, s10, 15
    s_and_b32 s11, s6, 3
    s_lshl_b32 s11, s11, 8
    s_add_u32 s10, s10, s11
    s_cmp_lg_u32 s9, 0
    s_cbranch_scc1 L_kfin
    v_mov_b32 v14, 0
    s_mov_b32 s15, 0
Lspin_44:
    ds_read_b32 v15, v14 offset:3096
    s_waitcnt lgkmcnt(0)
    v_readfirstlane_b32 s14, v15
    s_add_u32 s15, s15, 1
    s_cmp_ge_u32 s14, 4
    s_cbranch_scc1 Lspd_45
    s_cmp_gt_u32 s15, 16000000
    s_cbranch_scc1 Lspd_45
    s_sleep 1
    s_branch Lspin_44
Lspd_45:
    buffer_load_dword v3, v2, s[56:59], s10 offen
L_kfin:
    s_endpgm
.p2align 12
L_V:
Lhop_31:
    s_cbranch_execz Lhop_32
    v_mov_b32 v248, 0
    v_mov_b32 v249, 0
    v_mov_b32 v250, 0
    v_mov_b32 v251, 0
    v_mov_b32 v252, 0
    v_mov_b32 v253, 0
    v_mov_b32 v254, 0
    v_mov_b32 v255, 0
    v_and_b32 v2, 1, v0
    v_lshlrev_b32 v2, 4, v2
    v_mov_b32 v3, 0xffff
    v_lshlrev_b32 v2, v2, v3
    v_bfe_u32 v3, v0, 1, 2
    v_cmp_eq_u32 vcc, 0, v3
    s_nop 1
    v_cndmask_b32 v4, 0, v2, vcc
    v_cmp_eq_u32 vcc, 1, v3
    s_nop 1
    v_cndmask_b32 v5, 0, v2, vcc
    v_cmp_eq_u32 vcc, 2, v3
    s_nop 1
    v_cndmask_b32 v6, 0, v2, vcc
    v_cmp_eq_u32 vcc, 3, v3
    s_nop 1
    v_cndmask_b32 v7, 0, v2, vcc
    s_mov_b32 s48, s44
    s_and_b32 s49, s45, 0xffff
    s_mov_b32 s50, 1048576
    s_mov_b32 s51, 0x20000
    v_lshrrev_b32 v16, 3, v0
    v_mul_u32_u24 v16, 96, v16
    s_mul_i32 s10, s9, 768
    v_add_u32 v16, s10, v16
    s_lshl_b32 s10, s9, 2
    v_mov_b32 v17, s10
    v_and_b32 v9, 15, v0
    v_lshlrev_b32 v9, 5, v9
    v_and_b32 v8, 16, v0
    v_add_u32 v9, v9, v8
    v_lshrrev_b32 v8, 5, v0
    v_lshl_add_u32 v10, v8, 3, v9
    s_xor_b32 s10, s9, 0
    s_lshl_b32 s10, s10, 9
    v_lshl_add_u32 v64, v0, 3, s10
    s_xor_b32 s10, s9, 1
    s_lshl_b32 s10, s10, 9
    v_lshl_add_u32 v65, v0, 3, s10
    s_xor_b32 s10, s9, 2
    s_lshl_b32 s10, s10, 9
    v_lshl_add_u32 v66, v0, 3, s10
    s_xor_b32 s10, s9, 3
    s_lshl_b32 s10, s10, 9
    v_lshl_add_u32 v67, v0, 3, s10
    v_mov_b32 v68, 0
    v_mov_b32 v18, 1
    s_mov_b32 s76, 0
    s_mov_b32 s77, -1
    s_lshl_b32 s62, s6, 12
    s_lshl_b32 s11, s7, 9
    s_add_u32 s62, s62, s11
    s_add_u32 s62, s62, 131072
    s_add_u32 s63, s62, 524288
    s_waitcnt lgkmcnt(0)
    s_add_u32 s46, s46, 1
    s_and_b32 s47, s46, 0xff
    s_and_b32 s71, s46, 0xffff
    s_mov_b32 s72, 0xffffff00
    v_mov_b32 v11, s47
    buffer_load_dwordx4 v[80:83], v1, s[52:55], s12 offen nt
    s_add_u32 s12, s12, s13
    s_cmp_eq_u32 s12, s79
    s_cselect_b32 s12, 0, s12
    buffer_load_dwordx4 v[84:87], v1, s[52:55], s12 offen nt
    s_add_u32 s12, s12, s13
    s_cmp_eq_u32 s12, s79
    s_cselect_b32 s12, 0, s12
    buffer_load_dwordx4 v[88:91], v1, s[52:55], s12 offen nt
    s_add_u32 s12, s12, s13
    s_cmp_eq_u32 s12, s79
    s_cselect_b32 s12, 0, s12
    buffer_load_dwordx4 v[92:95], v1, s[52:55], s12 offen nt
    s_add_u32 s12, s12, s13
    s_cmp_eq_u32 s12, s79
    s_cselect_b32 s12, 0, s12
    buffer_load_dwordx4 v[96:99], v1, s[52:55], s12 offen nt
Lhop_32:
    s_cbranch_execz Lhop_33
    s_add_u32 s12, s12, s13
    s_cmp_eq_u32 s12, s79
    s_cselect_b32 s12, 0, s12
    buffer_load_dwordx4 v[100:103], v1, s[52:55], s12 offen nt
    s_add_u32 s12, s12, s13
    s_cmp_eq_u32 s12, s79
    s_cselect_b32 s12, 0, s12
    buffer_load_dwordx4 v[104:107], v1, s[52:55], s12 offen nt
    s_add_u32 s12, s12, s13
    s_cmp_eq_u32 s12, s79
    s_cselect_b32 s12, 0, s12
    buffer_load_dwordx4 v[108:111], v1, s[52:55], s12 offen nt
    s_add_u32 s12, s12, s13
    s_cmp_eq_u32 s12, s79
    s_cselect_b32 s12, 0, s12
    buffer_load_dwordx4 v[112:115], v1, s[52:55], s12 offen nt
    s_add_u32 s12, s12, s13
    s_cmp_eq_u32 s12, s79
    s_cselect_b32 s12, 0, s12
    buffer_load_dwordx4 v[116:119], v1, s[52:55], s12 offen nt
    s_add_u32 s12, s12, s13
    s_cmp_eq_u32 s12, s79
    s_cselect_b32 s12, 0, s12
    buffer_load_dwordx4 v[120:123], v1, s[52:55], s12 offen nt
    s_add_u32 s12, s12, s13
    s_cmp_eq_u32 s12, s79
    s_cselect_b32 s12, 0, s12
    buffer_load_dwordx4 v[124:127], v1, s[52:55], s12 offen nt
    s_add_u32 s12, s12, s13
    s_cmp_eq_u32 s12, s79
    s_cselect_b32 s12, 0, s12
    buffer_load_dwordx4 v[128:131], v1, s[52:55], s12 offen nt
    s_add_u32 s12, s12, s13
    s_cmp_eq_u32 s12, s79
    s_cselect_b32 s12, 0, s12
    buffer_load_dwordx4 v[132:135], v1, s[52:55], s12 offen nt
    s_add_u32 s12, s12, s13
    s_cmp_eq_u32 s12, s79
    s_cselect_b32 s12, 0, s12
    buffer_load_dwordx4 v[136:139], v1, s[52:55], s12 offen nt
    s_add_u32 s12, s12, s13
    s_cmp_eq_u32 s12, s79
    s_cselect_b32 s12, 0, s12
    buffer_load_dwordx4 v[140:143], v1, s[52:55], s12 offen nt
    s_add_u32 s12, s12, s13
    s_cmp_eq_u32 s12, s79
    s_cselect_b32 s12, 0, s12
    buffer_load_dwordx4 v[144:147], v1, s[52:55], s12 offen nt
    s_add_u32 s12, s12, s13
    s_cmp_eq_u32 s12, s79
    s_cselect_b32 s12, 0, s12
    buffer_load_dwordx4 v[148:151], v1, s[52:55], s12 offen nt
    s_add_u32 s12, s12, s13
    s_cmp_eq_u32 s12, s79
    s_cselect_b32 s12, 0, s12
    buffer_load_dwordx4 v[152:155], v1, s[52:55], s12 offen nt
    s_add_u32 s12, s12, s13
    s_cmp_eq_u32 s12, s79
    s_cselect_b32 s12, 0, s12
    buffer_load_dwordx4 v[156:159], v1, s[52:55], s12 offen nt
    s_add_u32 s12, s12, s13
    s_cmp_eq_u32 s12, s79
    s_cselect_b32 s12, 0, s12
    buffer_load_dwordx4 v[160:163], v1, s[52:55], s12 offen nt
    s_add_u32 s12, s12, s13
    s_cmp_eq_u32 s12, s79
    s_cselect_b32 s12, 0, s12
    buffer_load_dwordx4 v[164:167], v1, s[52:55], s12 offen nt
    s_add_u32 s12, s12, s13
    s_cmp_eq_u32 s12, s79
    s_cselect_b32 s12, 0, s12
    buffer_load_dwordx4 v[168:171], v1, s[52:55], s12 offen nt
    s_add_u32 s12, s12, s13
    s_cmp_eq_u32 s12, s79
    s_cselect_b32 s12, 0, s12
    buffer_load_dwordx4 v[172:175], v1, s[52:55], s12 offen nt
    s_add_u32 s12, s12, s13
    s_cmp_eq_u32 s12, s79
    s_cselect_b32 s12, 0, s12
    buffer_load_dwordx4 v[176:179], v1, s[52:55], s12 offen nt
    s_add_u32 s12, s12, s13
    s_cmp_eq_u32 s12, s79
    s_cselect_b32 s12, 0, s12
    buffer_load_dwordx4 v[180:183], v1, s[52:55], s12 offen nt
    s_add_u32 s12, s12, s13
    s_cmp_eq_u32 s12, s79
    s_cselect_b32 s12, 0, s12
    buffer_load_dwordx4 v[184:187], v1, s[52:55], s12 offen nt
    s_add_u32 s12, s12, s13
Lhop_33:
    s_cbranch_execz Lhop_34
    s_cmp_eq_u32 s12, s79
    s_cselect_b32 s12, 0, s12
    buffer_load_dwordx4 v[188:191], v1, s[52:55], s12 offen nt
    s_add_u32 s12, s12, s13
    s_cmp_eq_u32 s12, s79
    s_cselect_b32 s12, 0, s12
    buffer_load_dwordx4 v[192:195], v1, s[52:55], s12 offen nt
    s_add_u32 s12, s12, s13
    s_cmp_eq_u32 s12, s79
    s_cselect_b32 s12, 0, s12
    buffer_load_dwordx4 v[196:199], v1, s[52:55], s12 offen nt
    s_add_u32 s12, s12, s13
    s_cmp_eq_u32 s12, s79
    s_cselect_b32 s12, 0, s12
    buffer_load_dwordx4 v[200:203], v1, s[52:55], s12 offen nt
    s_add_u32 s12, s12, s13
    s_cmp_eq_u32 s12, s79
    s_cselect_b32 s12, 0, s12
    buffer_load_dwordx4 v[204:207], v1, s[52:55], s12 offen nt
    s_add_u32 s12, s12, s13
    s_cmp_eq_u32 s12, s79
    s_cselect_b32 s12, 0, s12
    buffer_load_dwordx4 v[208:211], v1, s[52:55], s12 offen nt
    s_add_u32 s12, s12, s13
    s_cmp_eq_u32 s12, s79
    s_cselect_b32 s12, 0, s12
    ds_read_b32 v19, v68 offset:3092
    ds_read_b128 v[12:15], v68 offset:3072
    ds_read_b32 v2, v17 offset:3072
    ds_read_b128 v[40:43], v16 offset:0
    ds_read_b128 v[44:47], v16 offset:16
    ds_read_b128 v[48:51], v16 offset:32
    ds_read_b128 v[52:55], v16 offset:48
    ds_read_b128 v[56:59], v16 offset:64
    ds_read_b128 v[60:63], v16 offset:80
    buffer_load_dwordx4 v[212:215], v1, s[52:55], s12 offen nt
    s_add_u32 s12, s12, s13
    s_cmp_eq_u32 s12, s79
    s_cselect_b32 s12, 0, s12
    s_waitcnt lgkmcnt(0)
    v_readfirstlane_b32 s14, v19
    s_cmp_lt_u32 s14, 4
    s_cbranch_scc1 L_plate
    v_max3_f32 v3, v12, v13, v14
    v_max_f32 v3, v3, v15
    v_sub_f32 v2, v2, v3
    v_mul_f32 v2, 0x3fb8aa3b, v2
    v_exp_f32 v2, v2
    v_and_b32 v24, v40, v4
    v_and_b32 v25, v40, v5
    v_and_b32 v26, v40, v6
    v_and_b32 v27, v40, v7
    buffer_load_dwordx4 v[216:219], v1, s[52:55], s12 offen nt
    s_add_u32 s12, s12, s13
    s_cmp_eq_u32 s12, s79
    s_cselect_b32 s12, 0, s12
    v_and_b32 v28, v41, v4
    v_and_b32 v29, v41, v5
    v_and_b32 v30, v41, v6
    v_and_b32 v31, v41, v7
    s_waitcnt vmcnt(31)
    v_mfma_f32_16x16x32_bf16 v[32:35], v[24:27], v[80:83], 0
    v_mfma_f32_16x16x32_bf16 v[36:39], v[24:27], v[84:87], 0
    v_and_b32 v24, v42, v4
    v_and_b32 v25, v42, v5
    v_and_b32 v26, v42, v6
    v_and_b32 v27, v42, v7
    v_mfma_f32_16x16x32_bf16 v[32:35], v[28:31], v[88:91], v[32:35]
    v_mfma_f32_16x16x32_bf16 v[36:39], v[28:31], v[92:95], v[36:39]
    buffer_load_dwordx4 v[220:223], v1, s[52:55], s12 offen nt
    s_add_u32 s12, s12, s13
    s_cmp_eq_u32 s12, s79
    s_cselect_b32 s12, 0, s12
    v_and_b32 v28, v43, v4
    v_and_b32 v29, v43, v5
    v_and_b32 v30, v43, v6
    v_and_b32 v31, v43, v7
    s_waitcnt vmcnt(28)
    v_mfma_f32_16x16x32_bf16 v[32:35], v[24:27], v[96:99], v[32:35]
    v_mfma_f32_16x16x32_bf16 v[36:39], v[24:27], v[100:103], v[36:39]
    v_and_b32 v24, v44, v4
    v_and_b32 v25, v44, v5
    v_and_b32 v26, v44, v6
    v_and_b32 v27, v44, v7
Lhop_34:
    s_cbranch_execz L_warmdonea
    v_mfma_f32_16x16x32_bf16 v[32:35], v[28:31], v[104:107], v[32:35]
    v_mfma_f32_16x16x32_bf16 v[36:39], v[28:31], v[108:111], v[36:39]
    buffer_load_dwordx4 v[224:227], v1, s[52:55], s12 offen nt
    s_add_u32 s12, s12, s13
    s_cmp_eq_u32 s12, s79
    s_cselect_b32 s12, 0, s12
    v_and_b32 v28, v45, v4
    v_and_b32 v29, v45, v5
    v_and_b32 v30, v45, v6
    v_and_b32 v31, v45, v7
    s_waitcnt vmcnt(25)
    v_mfma_f32_16x16x32_bf16 v[32:35], v[24:27], v[112:115], v[32:35]
    v_mfma_f32_16x16x32_bf16 v[36:39], v[24:27], v[116:119], v[36:39]
    v_and_b32 v24, v46, v4
    v_and_b32 v25, v46, v5
    v_and_b32 v26, v46, v6
    v_and_b32 v27, v46, v7
    v_mfma_f32_16x16x32_bf16 v[32:35], v[28:31], v[120:123], v[32:35]
    v_mfma_f32_16x16x32_bf16 v[36:39], v[28:31], v[124:127], v[36:39]
    buffer_load_dwordx4 v[228:231], v1, s[52:55], s12 offen nt
    s_add_u32 s12, s12, s13
    s_cmp_eq_u32 s12, s79
    s_cselect_b32 s12, 0, s12
    v_and_b32 v28, v47, v4
    v_and_b32 v29, v47, v5
    v_and_b32 v30, v47, v6
    v_and_b32 v31, v47, v7
    s_waitcnt vmcnt(22)
    v_mfma_f32_16x16x32_bf16 v[32:35], v[24:27], v[128:131], v[32:35]
    v_mfma_f32_16x16x32_bf16 v[36:39], v[24:27], v[132:135], v[36:39]
    v_and_b32 v24, v48, v4
    v_and_b32 v25, v48, v5
    v_and_b32 v26, v48, v6
    v_and_b32 v27, v48, v7
    v_mfma_f32_16x16x32_bf16 v[32:35], v[28:31], v[136:139], v[32:35]
    v_mfma_f32_16x16x32_bf16 v[36:39], v[28:31], v[140:143], v[36:39]
    buffer_load_dwordx4 v[232:235], v1, s[52:55], s12 offen nt
    s_add_u32 s12, s12, s13
    s_cmp_eq_u32 s12, s79
    s_cselect_b32 s12, 0, s12
    v_and_b32 v28, v49, v4
    v_and_b32 v29, v49, v5
    v_and_b32 v30, v49, v6
    v_and_b32 v31, v49, v7
    s_waitcnt vmcnt(19)
    v_mfma_f32_16x16x32_bf16 v[32:35], v[24:27], v[144:147], v[32:35]
    v_mfma_f32_16x16x32_bf16 v[36:39], v[24:27], v[148:151], v[36:39]
    v_and_b32 v24, v50, v4
    v_and_b32 v25, v50, v5
    v_and_b32 v26, v50, v6
    v_and_b32 v27, v50, v7
    v_mfma_f32_16x16x32_bf16 v[32:35], v[28:31], v[152:155], v[32:35]
    v_mfma_f32_16x16x32_bf16 v[36:39], v[28:31], v[156:159], v[36:39]
    buffer_load_dwordx4 v[236:239], v1, s[52:55], s12 offen nt
    s_add_u32 s12, s12, s13
    s_cmp_eq_u32 s12, s79
    s_cselect_b32 s12, 0, s12
    v_and_b32 v28, v51, v4
    v_and_b32 v29, v51, v5
    v_and_b32 v30, v51, v6
    v_and_b32 v31, v51, v7
    s_waitcnt vmcnt(16)
    v_mfma_f32_16x16x32_bf16 v[32:35], v[24:27], v[160:163], v[32:35]
    v_mfma_f32_16x16x32_bf16 v[36:39], v[24:27], v[164:167], v[36:39]
    v_and_b32 v24, v52, v4
    v_and_b32 v25, v52, v5
    v_and_b32 v26, v52, v6
    v_and_b32 v27, v52, v7
    v_mfma_f32_16x16x32_bf16 v[32:35], v[28:31], v[168:171], v[32:35]
    v_mfma_f32_16x16x32_bf16 v[36:39], v[28:31], v[172:175], v[36:39]
    buffer_load_dwordx4 v[240:243], v1, s[52:55], s12 offen nt
    s_add_u32 s12, s12, s13
    s_cmp_eq_u32 s12, s79
    s_cselect_b32 s12, 0, s12
    v_and_b32 v28, v53, v4
    v_and_b32 v29, v53, v5
    v_and_b32 v30, v53, v6
    v_and_b32 v31, v53, v7
    s_waitcnt vmcnt(15)
    v_mfma_f32_16x16x32_bf16 v[32:35], v[24:27], v[176:179], v[32:35]
    v_mfma_f32_16x16x32_bf16 v[36:39], v[24:27], v[180:183], v[36:39]
    buffer_load_dwordx4 v[244:247], v1, s[52:55], s12 offen nt
    s_add_u32 s12, s12, s13
    s_cmp_eq_u32 s12, s79
    s_cselect_b32 s12, 0, s12
Lhop_35:
    s_cbranch_execz Lhop_36
    s_cmp_eq_u32 s78, 0
    s_cbranch_scc1 Lskip_46
    buffer_load_dwordx4 v[248:251], v1, s[52:55], s12 offen nt
Lskip_46:
    s_mov_b64 exec, 1
    ds_add_u32 v68, v18 offset:3096
    s_mov_b64 exec, -1
L_pvb:
    v_and_b32 v24, v54, v4
    v_and_b32 v25, v54, v5
    v_and_b32 v26, v54, v6
    v_and_b32 v27, v54, v7
    s_waitcnt vmcnt(15)
    v_mfma_f32_16x16x32_bf16 v[32:35], v[28:31], v[184:187], v[32:35]
    s_waitcnt vmcnt(14)
    v_mfma_f32_16x16x32_bf16 v[36:39], v[28:31], v[188:191], v[36:39]
    v_and_b32 v28, v55, v4
    v_and_b32 v29, v55, v5
    v_and_b32 v30, v55, v6
    v_and_b32 v31, v55, v7
    s_waitcnt vmcnt(13)
    v_mfma_f32_16x16x32_bf16 v[32:35], v[24:27], v[192:195], v[32:35]
    s_waitcnt vmcnt(12)
    v_mfma_f32_16x16x32_bf16 v[36:39], v[24:27], v[196:199], v[36:39]
    v_and_b32 v24, v56, v4
    v_and_b32 v25, v56, v5
    v_and_b32 v26, v56, v6
    v_and_b32 v27, v56, v7
    s_waitcnt vmcnt(11)
    v_mfma_f32_16x16x32_bf16 v[32:35], v[28:31], v[200:203], v[32:35]
    s_waitcnt vmcnt(10)
    v_mfma_f32_16x16x32_bf16 v[36:39], v[28:31], v[204:207], v[36:39]
    v_and_b32 v28, v57, v4
    v_and_b32 v29, v57, v5
    v_and_b32 v30, v57, v6
    v_and_b32 v31, v57, v7
    s_waitcnt vmcnt(9)
    v_mfma_f32_16x16x32_bf16 v[32:35], v[24:27], v[208:211], v[32:35]
    s_waitcnt vmcnt(8)
    v_mfma_f32_16x16x32_bf16 v[36:39], v[24:27], v[212:215], v[36:39]
    v_and_b32 v24, v58, v4
    v_and_b32 v25, v58, v5
    v_and_b32 v26, v58, v6
    v_and_b32 v27, v58, v7
    s_waitcnt vmcnt(7)
    v_mfma_f32_16x16x32_bf16 v[32:35], v[28:31], v[216:219], v[32:35]
    s_waitcnt vmcnt(6)
    v_mfma_f32_16x16x32_bf16 v[36:39], v[28:31], v[220:223], v[36:39]
    v_and_b32 v28, v59, v4
    v_and_b32 v29, v59, v5
    v_and_b32 v30, v59, v6
    v_and_b32 v31, v59, v7
    s_waitcnt vmcnt(5)
    v_mfma_f32_16x16x32_bf16 v[32:35], v[24:27], v[224:227], v[32:35]
    s_waitcnt vmcnt(4)
    v_mfma_f32_16x16x32_bf16 v[36:39], v[24:27], v[228:231], v[36:39]
    v_and_b32 v24, v60, v4
    v_and_b32 v25, v60, v5
    v_and_b32 v26, v60, v6
    v_and_b32 v27, v60, v7
    s_waitcnt vmcnt(3)
    v_mfma_f32_16x16x32_bf16 v[32:35], v[28:31], v[232:235], v[32:35]
    s_waitcnt vmcnt(2)
    v_mfma_f32_16x16x32_bf16 v[36:39], v[28:31], v[236:239], v[36:39]
    v_and_b32 v28, v61, v4
    v_and_b32 v29, v61, v5
    v_and_b32 v30, v61, v6
    v_and_b32 v31, v61, v7
    s_waitcnt vmcnt(1)
    v_mfma_f32_16x16x32_bf16 v[32:35], v[24:27], v[240:243], v[32:35]
    s_waitcnt vmcnt(0)
    v_mfma_f32_16x16x32_bf16 v[36:39], v[24:27], v[244:247], v[36:39]
    v_mfma_f32_16x16x32_bf16 v[32:35], v[28:31], v[248:251], v[32:35]
    ds_read_b32 v76, v68 offset:3088
    ds_read_b64 v[70:71], v65 offset:4096
    ds_read_b64 v[72:73], v66 offset:4096
    ds_read_b64 v[74:75], v67 offset:4096
    s_nop 3
    v_cndmask_b32 v32, v32, v36, s[76:77]
    v_cndmask_b32 v33, v33, v37, s[76:77]
    v_cndmask_b32 v34, v34, v38, s[76:77]
    v_cndmask_b32 v35, v35, v39, s[76:77]
    s_nop 0
    v_permlane32_swap_b32 v32, v34
    v_permlane32_swap_b32 v33, v35
Lhop_36:
    s_cbranch_execz Lhop_37
    v_pk_add_f32 v[32:33], v[32:33], v[34:35]
    v_pk_mul_f32 v[32:33], v[32:33], v[2:3] op_sel:[0,0] op_sel_hi:[1,0]
    s_waitcnt lgkmcnt(0)
    v_readfirstlane_b32 s14, v76
    v_pk_add_f32 v[72:73], v[72:73], v[74:75]
    s_cmp_lg_u32 s14, 3
    s_cbranch_scc1 Ll4s_47
Ll4b_48:
    v_pk_add_f32 v[32:33], v[32:33], v[70:71]
    v_pk_add_f32 v[32:33], v[32:33], v[72:73]
    v_and_or_b32 v33, v33, s72, v11
    buffer_store_dwordx2 v[32:33], v10, s[48:51], s62 offen
    buffer_store_dwordx2 v[32:33], v10, s[48:51], s63 offen sc1
    s_mov_b64 exec, 15
    v_lshlrev_b32 v12, 4, v0
    ds_read_b128 v[40:43], v12 offset:3136
    s_lshl_b32 s10, s6, 9
    s_lshl_b32 s11, s7, 6
    s_add_u32 s10, s10, s11
    s_add_u32 s10, s10, 606208
    s_waitcnt lgkmcnt(0)
    buffer_store_dwordx4 v[40:43], v12, s[48:51], s10 offen sc1
L_vfin:
    s_endpgm
L_plate:
    buffer_load_dwordx4 v[216:219], v1, s[52:55], s12 offen nt
    s_add_u32 s12, s12, s13
    s_cmp_eq_u32 s12, s79
    s_cselect_b32 s12, 0, s12
    buffer_load_dwordx4 v[220:223], v1, s[52:55], s12 offen nt
    s_add_u32 s12, s12, s13
    s_cmp_eq_u32 s12, s79
    s_cselect_b32 s12, 0, s12
    buffer_load_dwordx4 v[224:227], v1, s[52:55], s12 offen nt
    s_add_u32 s12, s12, s13
    s_cmp_eq_u32 s12, s79
    s_cselect_b32 s12, 0, s12
    buffer_load_dwordx4 v[228:231], v1, s[52:55], s12 offen nt
    s_add_u32 s12, s12, s13
    s_cmp_eq_u32 s12, s79
    s_cselect_b32 s12, 0, s12
    buffer_load_dwordx4 v[232:235], v1, s[52:55], s12 offen nt
    s_add_u32 s12, s12, s13
    s_cmp_eq_u32 s12, s79
    s_cselect_b32 s12, 0, s12
    buffer_load_dwordx4 v[236:239], v1, s[52:55], s12 offen nt
    s_add_u32 s12, s12, s13
    s_cmp_eq_u32 s12, s79
    s_cselect_b32 s12, 0, s12
    buffer_load_dwordx4 v[240:243], v1, s[52:55], s12 offen nt
    s_add_u32 s12, s12, s13
    s_cmp_eq_u32 s12, s79
    s_cselect_b32 s12, 0, s12
    buffer_load_dwordx4 v[244:247], v1, s[52:55], s12 offen nt
    s_add_u32 s12, s12, s13
    s_cmp_eq_u32 s12, s79
    s_cselect_b32 s12, 0, s12
    s_cmp_eq_u32 s78, 0
    s_cbranch_scc1 Lskip_49
    buffer_load_dwordx4 v[248:251], v1, s[52:55], s12 offen nt
Lskip_49:
    s_mov_b64 exec, 1
    ds_add_u32 v68, v18 offset:3096
    s_mov_b64 exec, -1
    s_mov_b32 s15, 0
Lspin_50:
    ds_read_b32 v19, v68 offset:3092
    ds_read_b128 v[12:15], v68 offset:3072
    ds_read_b32 v2, v17 offset:3072
    ds_read_b128 v[40:43], v16 offset:0
    ds_read_b128 v[44:47], v16 offset:16
    ds_read_b128 v[48:51], v16 offset:32
    ds_read_b128 v[52:55], v16 offset:48
    ds_read_b128 v[56:59], v16 offset:64
    ds_read_b128 v[60:63], v16 offset:80
    s_waitcnt lgkmcnt(0)
    v_readfirstlane_b32 s14, v19
    s_add_u32 s15, s15, 1
    s_cmp_ge_u32 s14, 4
    s_cbranch_scc1 Lspd_51
    s_cmp_gt_u32 s15, 16000000
    s_cbranch_scc1 Lspd_51
    s_sleep 1
    s_branch Lspin_50
Lspd_51:
Lhop_37:
    s_cbranch_execz Lhop_38
    v_max3_f32 v3, v12, v13, v14
    v_max_f32 v3, v3, v15
    v_sub_f32 v2, v2, v3
    v_mul_f32 v2, 0x3fb8aa3b, v2
    v_exp_f32 v2, v2
    v_and_b32 v24, v40, v4
    v_and_b32 v25, v40, v5
    v_and_b32 v26, v40, v6
    v_and_b32 v27, v40, v7
    v_and_b32 v28, v41, v4
    v_and_b32 v29, v41, v5
    v_and_b32 v30, v41, v6
    v_and_b32 v31, v41, v7
    s_waitcnt vmcnt(16)
    v_mfma_f32_16x16x32_bf16 v[32:35], v[24:27], v[80:83], 0
    v_mfma_f32_16x16x32_bf16 v[36:39], v[24:27], v[84:87], 0
    v_and_b32 v24, v42, v4
    v_and_b32 v25, v42, v5
    v_and_b32 v26, v42, v6
    v_and_b32 v27, v42, v7
    v_mfma_f32_16x16x32_bf16 v[32:35], v[28:31], v[88:91], v[32:35]
    v_mfma_f32_16x16x32_bf16 v[36:39], v[28:31], v[92:95], v[36:39]
    v_and_b32 v28, v43, v4
    v_and_b32 v29, v43, v5
    v_and_b32 v30, v43, v6
    v_and_b32 v31, v43, v7
    v_mfma_f32_16x16x32_bf16 v[32:35], v[24:27], v[96:99], v[32:35]
    v_mfma_f32_16x16x32_bf16 v[36:39], v[24:27], v[100:103], v[36:39]
    v_and_b32 v24, v44, v4
    v_and_b32 v25, v44, v5
    v_and_b32 v26, v44, v6
    v_and_b32 v27, v44, v7
    v_mfma_f32_16x16x32_bf16 v[32:35], v[28:31], v[104:107], v[32:35]
    v_mfma_f32_16x16x32_bf16 v[36:39], v[28:31], v[108:111], v[36:39]
    v_and_b32 v28, v45, v4
    v_and_b32 v29, v45, v5
    v_and_b32 v30, v45, v6
    v_and_b32 v31, v45, v7
    v_mfma_f32_16x16x32_bf16 v[32:35], v[24:27], v[112:115], v[32:35]
    v_mfma_f32_16x16x32_bf16 v[36:39], v[24:27], v[116:119], v[36:39]
    v_and_b32 v24, v46, v4
    v_and_b32 v25, v46, v5
    v_and_b32 v26, v46, v6
    v_and_b32 v27, v46, v7
    v_mfma_f32_16x16x32_bf16 v[32:35], v[28:31], v[120:123], v[32:35]
    v_mfma_f32_16x16x32_bf16 v[36:39], v[28:31], v[124:127], v[36:39]
    v_and_b32 v28, v47, v4
    v_and_b32 v29, v47, v5
    v_and_b32 v30, v47, v6
    v_and_b32 v31, v47, v7
    v_mfma_f32_16x16x32_bf16 v[32:35], v[24:27], v[128:131], v[32:35]
    v_mfma_f32_16x16x32_bf16 v[36:39], v[24:27], v[132:135], v[36:39]
    v_and_b32 v24, v48, v4
    v_and_b32 v25, v48, v5
    v_and_b32 v26, v48, v6
    v_and_b32 v27, v48, v7
    v_mfma_f32_16x16x32_bf16 v[32:35], v[28:31], v[136:139], v[32:35]
    v_mfma_f32_16x16x32_bf16 v[36:39], v[28:31], v[140:143], v[36:39]
    v_and_b32 v28, v49, v4
    v_and_b32 v29, v49, v5
    v_and_b32 v30, v49, v6
    v_and_b32 v31, v49, v7
    v_mfma_f32_16x16x32_bf16 v[32:35], v[24:27], v[144:147], v[32:35]
    v_mfma_f32_16x16x32_bf16 v[36:39], v[24:27], v[148:151], v[36:39]
    v_and_b32 v24, v50, v4
    v_and_b32 v25, v50, v5
    v_and_b32 v26, v50, v6
    v_and_b32 v27, v50, v7
    v_mfma_f32_16x16x32_bf16 v[32:35], v[28:31], v[152:155], v[32:35]
    v_mfma_f32_16x16x32_bf16 v[36:39], v[28:31], v[156:159], v[36:39]
    v_and_b32 v28, v51, v4
    v_and_b32 v29, v51, v5
    v_and_b32 v30, v51, v6
    v_and_b32 v31, v51, v7
    v_mfma_f32_16x16x32_bf16 v[32:35], v[24:27], v[160:163], v[32:35]
    v_mfma_f32_16x16x32_bf16 v[36:39], v[24:27], v[164:167], v[36:39]
    v_and_b32 v24, v52, v4
    v_and_b32 v25, v52, v5
    v_and_b32 v26, v52, v6
    v_and_b32 v27, v52, v7
    v_mfma_f32_16x16x32_bf16 v[32:35], v[28:31], v[168:171], v[32:35]
    v_mfma_f32_16x16x32_bf16 v[36:39], v[28:31], v[172:175], v[36:39]
    v_and_b32 v28, v53, v4
    v_and_b32 v29, v53, v5
    v_and_b32 v30, v53, v6
Lhop_38:
    s_cbranch_execz L_warmdonea
    v_and_b32 v31, v53, v7
    v_mfma_f32_16x16x32_bf16 v[32:35], v[24:27], v[176:179], v[32:35]
    v_mfma_f32_16x16x32_bf16 v[36:39], v[24:27], v[180:183], v[36:39]
    s_nop 1
    s_branch L_pvb
Ll4s_47:
    ds_write_b64 v64, v[32:33] offset:4096
    v_mov_b32 v76, 1
    s_mov_b64 exec, 1
    ds_add_rtn_u32 v76, v68, v76 offset:3088
    s_mov_b64 exec, -1
    ds_read_b64 v[70:71], v65 offset:4096
    ds_read_b64 v[72:73], v66 offset:4096
    ds_read_b64 v[74:75], v67 offset:4096
    s_waitcnt lgkmcnt(0)
    v_readfirstlane_b32 s14, v76
    v_pk_add_f32 v[72:73], v[72:73], v[74:75]
    s_cmp_lg_u32 s14, 3
    s_cbranch_scc1 L_vfin
    s_nop 1
    s_branch Ll4b_48
L_A1:
L_end:
    s_endpgm
.section .rodata,"a"
.p2align 6
.amdhsa_kernel adaLN_cond__mha_block_cached__mixer_channel_mlp__decode_kernel
  .amdhsa_next_free_vgpr 256
  .amdhsa_next_free_sgpr 102
  .amdhsa_accum_offset 256
  .amdhsa_group_segment_fixed_size 0
  .amdhsa_kernarg_size 120
  .amdhsa_user_sgpr_count 2
  .amdhsa_user_sgpr_kernarg_segment_ptr 1
  .amdhsa_system_sgpr_workgroup_id_x 1
  .amdhsa_float_denorm_mode_32 3
.end_amdhsa_kernel
```
